```python
import torch

def _softmax(x, axis=-1):
    return torch.softmax(x, dim=axis)
def _gelu(x):
    return torch.nn.functional.gelu(x, approximate="tanh")
def _silu(x):
    return torch.nn.functional.silu(x)
def _sigmoid(x):
    return torch.sigmoid(x)
def _layernorm(x, axis=-1, eps=1e-5):
    m = x.mean(dim=axis, keepdim=True)
    v = x.var(dim=axis, keepdim=True, unbiased=False)
    return (x - m) / torch.sqrt(v + eps)
def _scatter_add(tgt, idx, src, axis=0):
    return tgt.clone().index_add_(axis, idx, src)
def _segment_sum(src, seg, n):
    out = torch.zeros((n,) + src.shape[1:], dtype=src.dtype)
    return out.index_add_(0, seg, src)
def _pad(x, pw):
    flat = tuple(v for pair in reversed(pw) for v in pair)
    return torch.nn.functional.pad(x, flat)

kernel_name = 'concat_heads__gqa_block_cached__gqa_block_cached__near_ridge'

def setup_inputs():

    _w = (lambda a: (lambda t: t.to(torch.bfloat16) if t.is_floating_point() else t)(torch.as_tensor(a)))
    def _A_setup():
        B, Sq, D = 8, 96, 512
        Hq, Hkv, Sk, Dh = 32, 32, 512, 128
        assert Hq % Hkv == 0, (Hq, Hkv)
        return {
            "x": _w((lambda *s: torch.randn(*s, dtype=torch.bfloat16) * 0.8)(B, Sq, D)),
            "k_cache": _w((lambda *s: torch.randn(*s, dtype=torch.bfloat16) * 0.8)(B, Hkv, Sk, Dh)),
            "v_cache": _w((lambda *s: torch.randn(*s, dtype=torch.bfloat16) * 0.05)(B, Hkv, Sk, Dh)),
            "wq": _w((lambda *s: torch.randn(*s, dtype=torch.bfloat16) * 0.8)(D, Hq * Dh) * (D ** -0.5)),
            "wo": _w((lambda *s: torch.randn(*s, dtype=torch.bfloat16) * 0.05)(Hq * Dh, D) * ((Hq * Dh) ** -0.5)),
        }
    _A_in = _A_setup()

    def _B_setup():
        B, Sq, D = 8, 96, 512
        Hq, Hkv, Sk, Dh = 32, 32, 512, 128
        assert Hq % Hkv == 0, (Hq, Hkv)
        return {
            "x": _w((lambda *s: torch.randn(*s, dtype=torch.bfloat16) * 0.8)(B, Sq, D)),
            "k_cache": _w((lambda *s: torch.randn(*s, dtype=torch.bfloat16) * 0.8)(B, Hkv, Sk, Dh)),
            "v_cache": _w((lambda *s: torch.randn(*s, dtype=torch.bfloat16) * 0.05)(B, Hkv, Sk, Dh)),
            "wq": _w((lambda *s: torch.randn(*s, dtype=torch.bfloat16) * 0.8)(D, Hq * Dh) * (D ** -0.5)),
            "wo": _w((lambda *s: torch.randn(*s, dtype=torch.bfloat16) * 0.05)(Hq * Dh, D) * ((Hq * Dh) ** -0.5)),
        }
    _B_in = _B_setup()

    return {
        "A_x": _A_in["x"],
        "A_k_cache": _A_in["k_cache"],
        "A_v_cache": _A_in["v_cache"],
        "A_wq": _A_in["wq"],
        "A_wo": _A_in["wo"],
        "B_x": _B_in["x"],
        "B_k_cache": _B_in["k_cache"],
        "B_v_cache": _B_in["v_cache"],
        "B_wq": _B_in["wq"],
        "B_wo": _B_in["wo"],
    }

def reference(A_x, A_k_cache, A_v_cache, A_wq, A_wo, B_x, B_k_cache, B_v_cache, B_wq, B_wo):
    def _A_ref(x, k_cache, v_cache, wq, wo):
        B, Sq, D = x.shape
        Hq, Dh = 32, 128
        Hkv = k_cache.shape[1]
        rep = Hq // Hkv
        q = (lambda x, *d: x.permute(*d))((x @ wq).reshape(B, Sq, Hq, Dh), 0, 2, 1, 3)
        k = (lambda x, n, axis: torch.repeat_interleave(x, n, dim=axis))(k_cache, rep, axis=1)
        v = (lambda x, n, axis: torch.repeat_interleave(x, n, dim=axis))(v_cache, rep, axis=1)
        scores = torch.einsum("bhqd,bhkd->bhqk", q, k) * (Dh ** -0.5)
        p = _softmax(scores, axis=-1)
        o = torch.einsum("bhqk,bhkd->bhqd", p, v)
        return (lambda x, *d: x.permute(*d))(o, 0, 2, 1, 3).reshape(B, Sq, Hq * Dh) @ wo

    def _B_ref(x, k_cache, v_cache, wq, wo):
        B, Sq, D = x.shape
        Hq, Dh = 32, 128
        Hkv = k_cache.shape[1]
        rep = Hq // Hkv
        q = (lambda x, *d: x.permute(*d))((x @ wq).reshape(B, Sq, Hq, Dh), 0, 2, 1, 3)
        k = (lambda x, n, axis: torch.repeat_interleave(x, n, dim=axis))(k_cache, rep, axis=1)
        v = (lambda x, n, axis: torch.repeat_interleave(x, n, dim=axis))(v_cache, rep, axis=1)
        scores = torch.einsum("bhqd,bhkd->bhqk", q, k) * (Dh ** -0.5)
        p = _softmax(scores, axis=-1)
        o = torch.einsum("bhqk,bhkd->bhqd", p, v)
        return (lambda x, *d: x.permute(*d))(o, 0, 2, 1, 3).reshape(B, Sq, Hq * Dh) @ wo

    a = _A_ref(A_x, A_k_cache, A_v_cache, A_wq, A_wo)
    b = _B_ref(B_x, B_k_cache, B_v_cache, B_wq, B_wo)
    return torch.concatenate([a, b], axis=-1)
```

```asm
; @launch kernel=attn_kernel grid=(512,1,1) block=(256,1,1) lds=65536
; @launch kernel=oproj_kernel grid=(256,1,1) block=(256,1,1) lds=65536
; @launch kernel=reduce_kernel grid=(768,1,1) block=(256,1,1) lds=0
.amdgcn_target "amdgcn-amd-amdhsa--gfx950"
.text
.globl attn_kernel
.p2align 8
.type attn_kernel,@function
attn_kernel:
    s_cmp_ge_u32 s2, 512
    s_cbranch_scc1 K1_exit
    s_lshr_b32 s3, s2, 8
    s_bfe_u32 s4, s2, 0x30005
    s_and_b32 s5, s2, 31
    s_mul_i32 s40, s3, 40
    s_add_u32 s42, s0, s40
    s_addc_u32 s43, s1, 0
    s_load_dwordx8 s[8:15], s[42:43], 0
    s_load_dwordx2 s[16:17], s[0:1], 96
    v_lshrrev_b32 v1, 6, v0
    s_nop 0
    v_readfirstlane_b32 s6, v1
    s_waitcnt lgkmcnt(0)
    s_mul_i32 s40, s4, 98304
    s_add_u32 s8, s8, s40
    s_addc_u32 s9, s9, 0
    s_mov_b32 s20, s8
    s_and_b32 s21, s9, 0xffff
    s_mov_b32 s22, 98304
    s_mov_b32 s23, 0x20000
    s_lshl_b32 s40, s4, 5
    s_add_u32 s40, s40, s5
    s_lshl_b32 s40, s40, 17
    s_add_u32 s10, s10, s40
    s_addc_u32 s11, s11, 0
    s_add_u32 s12, s12, s40
    s_addc_u32 s13, s13, 0
    s_mov_b32 s24, s10
    s_and_b32 s25, s11, 0xffff
    s_mov_b32 s26, 131072
    s_mov_b32 s27, 0x20000
    s_mov_b32 s28, s12
    s_and_b32 s29, s13, 0xffff
    s_mov_b32 s30, 131072
    s_mov_b32 s31, 0x20000
    s_lshl_b32 s40, s5, 8
    s_add_u32 s14, s14, s40
    s_addc_u32 s15, s15, 0
    s_sub_u32 s41, 4194304, s40
    s_mov_b32 s32, s14
    s_and_b32 s33, s15, 0xffff
    s_mov_b32 s34, s41
    s_mov_b32 s35, 0x20000
    s_lshl_b32 s41, s3, 3
    s_add_u32 s41, s41, s4
    s_mul_i32 s41, s41, 786432
    s_add_u32 s41, s41, s40
    s_add_u32 s16, s16, s41
    s_addc_u32 s17, s17, 0
    s_sub_u32 s41, 786432, s40
    s_mov_b32 s36, s16
    s_and_b32 s37, s17, 0xffff
    s_mov_b32 s38, s41
    s_mov_b32 s39, 0x20000
    s_cmp_eq_u32 s6, 3
    s_cbranch_scc1 K1_producer
    v_and_b32 v1, 63, v0
    v_and_b32 v2, 31, v1
    v_lshrrev_b32 v3, 5, v1
    v_bfe_u32 v4, v1, 4, 1
    v_bfe_u32 v5, v1, 2, 2
    v_and_b32 v6, 3, v1
    v_and_b32 v7, 1, v6
    v_lshrrev_b32 v8, 1, v6
    v_lshl_add_u32 v7, v4, 1, v7
    v_mul_u32_u24 v9, 8, v3
    v_add_u32 v9, v9, v5
    v_lshlrev_b32 v9, 8, v9
    v_lshl_add_u32 v9, v8, 3, v9
    v_lshlrev_b32 v8, 2, v5
    v_add_u32 v204, 0, v7
    v_xor_b32 v204, v204, v8
    v_lshl_add_u32 v204, v204, 4, v9
    v_add_u32 v205, 4, v7
    v_xor_b32 v205, v205, v8
    v_lshl_add_u32 v205, v205, 4, v9
    v_add_u32 v206, 8, v7
    v_xor_b32 v206, v206, v8
    v_lshl_add_u32 v206, v206, 4, v9
    v_add_u32 v207, 12, v7
    v_xor_b32 v207, v207, v8
    v_lshl_add_u32 v207, v207, 4, v9
    v_lshrrev_b32 v7, 1, v6
    v_and_b32 v8, 1, v6
    v_lshl_add_u32 v7, v4, 1, v7
    v_mul_u32_u24 v9, 4, v3
    v_add_u32 v9, v9, v5
    v_lshlrev_b32 v9, 8, v9
    v_lshl_add_u32 v9, v8, 3, v9
    v_lshlrev_b32 v8, 2, v5
    v_add_u32 v200, 0, v7
    v_xor_b32 v200, v200, v8
    v_lshl_add_u32 v200, v200, 4, v9
    v_add_u32 v201, 4, v7
    v_xor_b32 v201, v201, v8
    v_lshl_add_u32 v201, v201, 4, v9
    v_add_u32 v202, 8, v7
    v_xor_b32 v202, v202, v8
    v_lshl_add_u32 v202, v202, 4, v9
    v_add_u32 v203, 12, v7
    v_xor_b32 v203, v203, v8
    v_lshl_add_u32 v203, v203, 4, v9
    v_and_b32 v7, 15, v2
    v_add_u32 v192, 0, v3
    v_xor_b32 v192, v192, v7
    v_lshlrev_b32 v192, 4, v192
    v_lshl_add_u32 v192, v2, 8, v192
    v_add_u32 v193, 2, v3
    v_xor_b32 v193, v193, v7
    v_lshlrev_b32 v193, 4, v193
    v_lshl_add_u32 v193, v2, 8, v193
    v_add_u32 v194, 4, v3
    v_xor_b32 v194, v194, v7
    v_lshlrev_b32 v194, 4, v194
    v_lshl_add_u32 v194, v2, 8, v194
    v_add_u32 v195, 6, v3
    v_xor_b32 v195, v195, v7
    v_lshlrev_b32 v195, 4, v195
    v_lshl_add_u32 v195, v2, 8, v195
    v_add_u32 v196, 8, v3
    v_xor_b32 v196, v196, v7
    v_lshlrev_b32 v196, 4, v196
    v_lshl_add_u32 v196, v2, 8, v196
    v_add_u32 v197, 10, v3
    v_xor_b32 v197, v197, v7
    v_lshlrev_b32 v197, 4, v197
    v_lshl_add_u32 v197, v2, 8, v197
    v_add_u32 v198, 12, v3
    v_xor_b32 v198, v198, v7
    v_lshlrev_b32 v198, 4, v198
    v_lshl_add_u32 v198, v2, 8, v198
    v_add_u32 v199, 14, v3
    v_xor_b32 v199, v199, v7
    v_lshlrev_b32 v199, 4, v199
    v_lshl_add_u32 v199, v2, 8, v199
    s_lshl_b32 s40, s6, 5
    v_add_u32 v7, s40, v2
    v_lshlrev_b32 v208, 10, v7
    v_lshl_add_u32 v208, v3, 4, v208
    v_lshlrev_b32 v214, 13, v7
    v_lshl_add_u32 v214, v3, 3, v214
    v_and_b32 v20, 63, v0
    v_lshrrev_b32 v21, 4, v20
    v_and_b32 v22, 15, v20
    v_add_u32 v23, 0, v21
    v_xor_b32 v23, v23, v22
    v_lshlrev_b32 v23, 4, v23
    v_lshl_add_u32 v216, v21, 8, v23
    v_add_u32 v23, 4, v21
    v_xor_b32 v23, v23, v22
    v_lshlrev_b32 v23, 4, v23
    v_lshl_add_u32 v217, v21, 8, v23
    v_add_u32 v23, 8, v21
    v_xor_b32 v23, v23, v22
    v_lshlrev_b32 v23, 4, v23
    v_lshl_add_u32 v218, v21, 8, v23
    v_add_u32 v23, 12, v21
    v_xor_b32 v23, v23, v22
    v_lshlrev_b32 v23, 4, v23
    v_lshl_add_u32 v219, v21, 8, v23
    v_lshlrev_b32 v23, 2, v21
    v_xor_b32 v23, v23, v22
    v_lshlrev_b32 v23, 4, v23
    v_lshl_add_u32 v220, v21, 8, v23
    v_mul_u32_u24 v24, 8192, v21
    v_add_u32 v221, v24, v23
    s_lshl_b32 s44, s6, 12
    s_mul_i32 s45, s6, 131072
    s_add_u32 m0, s44, 0
    s_add_u32 s40, s45, 0
    buffer_load_dwordx4 v221, s[32:35], s40 offen offset:0 lds
    s_add_u32 s40, s45, 31744
    buffer_load_dwordx4 v221, s[32:35], s40 offen offset:1024 lds
    s_add_u32 s40, s45, 63488
    buffer_load_dwordx4 v221, s[32:35], s40 offen offset:2048 lds
    s_add_u32 s40, s45, 95232
    buffer_load_dwordx4 v221, s[32:35], s40 offen offset:3072 lds
    s_add_u32 m0, s44, 16384
    s_add_u32 s40, s45, 524288
    buffer_load_dwordx4 v221, s[32:35], s40 offen offset:0 lds
    s_add_u32 s40, s45, 556032
    buffer_load_dwordx4 v221, s[32:35], s40 offen offset:1024 lds
    s_add_u32 s40, s45, 587776
    buffer_load_dwordx4 v221, s[32:35], s40 offen offset:2048 lds
    s_add_u32 s40, s45, 619520
    buffer_load_dwordx4 v221, s[32:35], s40 offen offset:3072 lds
    s_add_u32 m0, s44, 32768
    s_add_u32 s40, s45, 1048576
    buffer_load_dwordx4 v221, s[32:35], s40 offen offset:0 lds
    s_add_u32 s40, s45, 1080320
    buffer_load_dwordx4 v221, s[32:35], s40 offen offset:1024 lds
    s_add_u32 s40, s45, 1112064
    buffer_load_dwordx4 v221, s[32:35], s40 offen offset:2048 lds
    s_add_u32 s40, s45, 1143808
    buffer_load_dwordx4 v221, s[32:35], s40 offen offset:3072 lds
    buffer_load_dwordx4 v[128:131], v208, s[20:23], 0 offen offset:0
    buffer_load_dwordx4 v[132:135], v208, s[20:23], 0 offen offset:32
    buffer_load_dwordx4 v[136:139], v208, s[20:23], 0 offen offset:64
    buffer_load_dwordx4 v[140:143], v208, s[20:23], 0 offen offset:96
    s_waitcnt vmcnt(12)
    s_barrier
    buffer_load_dwordx4 v[144:147], v208, s[20:23], 0 offen offset:128
    buffer_load_dwordx4 v[148:151], v208, s[20:23], 0 offen offset:160
    buffer_load_dwordx4 v[152:155], v208, s[20:23], 0 offen offset:192
    buffer_load_dwordx4 v[156:159], v208, s[20:23], 0 offen offset:224
    s_add_u32 m0, s44, 49152
    s_add_u32 s40, s45, 1572864
    buffer_load_dwordx4 v221, s[32:35], s40 offen offset:0 lds
    s_add_u32 s40, s45, 1604608
    buffer_load_dwordx4 v221, s[32:35], s40 offen offset:1024 lds
    s_add_u32 s40, s45, 1636352
    buffer_load_dwordx4 v221, s[32:35], s40 offen offset:2048 lds
    s_add_u32 s40, s45, 1668096
    buffer_load_dwordx4 v221, s[32:35], s40 offen offset:3072 lds
    s_waitcnt vmcnt(8)
    ds_read_b64_tr_b16 v[176:176+1], v204 offset:0
    ds_read_b64_tr_b16 v[178:178+1], v204 offset:1024
    ds_read_b64_tr_b16 v[180:180+1], v205 offset:0
    ds_read_b64_tr_b16 v[182:182+1], v205 offset:1024
    ds_read_b64_tr_b16 v[184:184+1], v206 offset:0
    ds_read_b64_tr_b16 v[186:186+1], v206 offset:1024
    ds_read_b64_tr_b16 v[188:188+1], v207 offset:0
    ds_read_b64_tr_b16 v[190:190+1], v207 offset:1024
    s_waitcnt lgkmcnt(6)
    v_mfma_f32_32x32x16_bf16 v[64:79], v[176:179], v[128:131], 0
    ds_read_b64_tr_b16 v[176:176+1], v204 offset:4096
    ds_read_b64_tr_b16 v[178:178+1], v204 offset:5120
    s_waitcnt lgkmcnt(6)
    v_mfma_f32_32x32x16_bf16 v[80:95], v[180:183], v[128:131], 0
    ds_read_b64_tr_b16 v[180:180+1], v205 offset:4096
    ds_read_b64_tr_b16 v[182:182+1], v205 offset:5120
    s_waitcnt lgkmcnt(6)
    v_mfma_f32_32x32x16_bf16 v[96:111], v[184:187], v[128:131], 0
    ds_read_b64_tr_b16 v[184:184+1], v206 offset:4096
    ds_read_b64_tr_b16 v[186:186+1], v206 offset:5120
    s_waitcnt lgkmcnt(6)
    v_mfma_f32_32x32x16_bf16 v[112:127], v[188:191], v[128:131], 0
    ds_read_b64_tr_b16 v[188:188+1], v207 offset:4096
    ds_read_b64_tr_b16 v[190:190+1], v207 offset:5120
    s_waitcnt lgkmcnt(6)
    v_mfma_f32_32x32x16_bf16 v[64:79], v[176:179], v[132:135], v[64:79]
    ds_read_b64_tr_b16 v[176:176+1], v204 offset:8192
    ds_read_b64_tr_b16 v[178:178+1], v204 offset:9216
    s_waitcnt lgkmcnt(6)
    v_mfma_f32_32x32x16_bf16 v[80:95], v[180:183], v[132:135], v[80:95]
    ds_read_b64_tr_b16 v[180:180+1], v205 offset:8192
    ds_read_b64_tr_b16 v[182:182+1], v205 offset:9216
    s_waitcnt lgkmcnt(6)
    v_mfma_f32_32x32x16_bf16 v[96:111], v[184:187], v[132:135], v[96:111]
    ds_read_b64_tr_b16 v[184:184+1], v206 offset:8192
    ds_read_b64_tr_b16 v[186:186+1], v206 offset:9216
    s_waitcnt lgkmcnt(6)
    v_mfma_f32_32x32x16_bf16 v[112:127], v[188:191], v[132:135], v[112:127]
    ds_read_b64_tr_b16 v[188:188+1], v207 offset:8192
    ds_read_b64_tr_b16 v[190:190+1], v207 offset:9216
    s_waitcnt lgkmcnt(6)
    v_mfma_f32_32x32x16_bf16 v[64:79], v[176:179], v[136:139], v[64:79]
    ds_read_b64_tr_b16 v[176:176+1], v204 offset:12288
    ds_read_b64_tr_b16 v[178:178+1], v204 offset:13312
    s_waitcnt lgkmcnt(6)
    v_mfma_f32_32x32x16_bf16 v[80:95], v[180:183], v[136:139], v[80:95]
    ds_read_b64_tr_b16 v[180:180+1], v205 offset:12288
    ds_read_b64_tr_b16 v[182:182+1], v205 offset:13312
    s_waitcnt lgkmcnt(6)
    v_mfma_f32_32x32x16_bf16 v[96:111], v[184:187], v[136:139], v[96:111]
    ds_read_b64_tr_b16 v[184:184+1], v206 offset:12288
    ds_read_b64_tr_b16 v[186:186+1], v206 offset:13312
    s_waitcnt lgkmcnt(6)
    v_mfma_f32_32x32x16_bf16 v[112:127], v[188:191], v[136:139], v[112:127]
    ds_read_b64_tr_b16 v[188:188+1], v207 offset:12288
    ds_read_b64_tr_b16 v[190:190+1], v207 offset:13312
    s_waitcnt lgkmcnt(6)
    v_mfma_f32_32x32x16_bf16 v[64:79], v[176:179], v[140:143], v[64:79]
    s_waitcnt lgkmcnt(4)
    v_mfma_f32_32x32x16_bf16 v[80:95], v[180:183], v[140:143], v[80:95]
    s_waitcnt lgkmcnt(2)
    v_mfma_f32_32x32x16_bf16 v[96:111], v[184:187], v[140:143], v[96:111]
    s_waitcnt lgkmcnt(0)
    v_mfma_f32_32x32x16_bf16 v[112:127], v[188:191], v[140:143], v[112:127]
    s_waitcnt vmcnt(16)
    s_barrier
    buffer_load_dwordx4 v[128:131], v208, s[20:23], 0 offen offset:256
    buffer_load_dwordx4 v[132:135], v208, s[20:23], 0 offen offset:288
    buffer_load_dwordx4 v[136:139], v208, s[20:23], 0 offen offset:320
    buffer_load_dwordx4 v[140:143], v208, s[20:23], 0 offen offset:352
    s_add_u32 m0, s44, 0
    s_add_u32 s40, s45, 2097152
    buffer_load_dwordx4 v221, s[32:35], s40 offen offset:0 lds
    s_add_u32 s40, s45, 2128896
    buffer_load_dwordx4 v221, s[32:35], s40 offen offset:1024 lds
    s_add_u32 s40, s45, 2160640
    buffer_load_dwordx4 v221, s[32:35], s40 offen offset:2048 lds
    s_add_u32 s40, s45, 2192384
    buffer_load_dwordx4 v221, s[32:35], s40 offen offset:3072 lds
    s_waitcnt vmcnt(12)
    ds_read_b64_tr_b16 v[176:176+1], v204 offset:16384
    ds_read_b64_tr_b16 v[178:178+1], v204 offset:17408
    ds_read_b64_tr_b16 v[180:180+1], v205 offset:16384
    ds_read_b64_tr_b16 v[182:182+1], v205 offset:17408
    ds_read_b64_tr_b16 v[184:184+1], v206 offset:16384
    ds_read_b64_tr_b16 v[186:186+1], v206 offset:17408
    ds_read_b64_tr_b16 v[188:188+1], v207 offset:16384
    ds_read_b64_tr_b16 v[190:190+1], v207 offset:17408
    s_waitcnt lgkmcnt(6)
    v_mfma_f32_32x32x16_bf16 v[64:79], v[176:179], v[144:147], v[64:79]
    ds_read_b64_tr_b16 v[176:176+1], v204 offset:20480
    ds_read_b64_tr_b16 v[178:178+1], v204 offset:21504
    s_waitcnt lgkmcnt(6)
    v_mfma_f32_32x32x16_bf16 v[80:95], v[180:183], v[144:147], v[80:95]
    ds_read_b64_tr_b16 v[180:180+1], v205 offset:20480
    ds_read_b64_tr_b16 v[182:182+1], v205 offset:21504
    s_waitcnt lgkmcnt(6)
    v_mfma_f32_32x32x16_bf16 v[96:111], v[184:187], v[144:147], v[96:111]
    ds_read_b64_tr_b16 v[184:184+1], v206 offset:20480
    ds_read_b64_tr_b16 v[186:186+1], v206 offset:21504
    s_waitcnt lgkmcnt(6)
    v_mfma_f32_32x32x16_bf16 v[112:127], v[188:191], v[144:147], v[112:127]
    ds_read_b64_tr_b16 v[188:188+1], v207 offset:20480
    ds_read_b64_tr_b16 v[190:190+1], v207 offset:21504
    s_waitcnt lgkmcnt(6)
    v_mfma_f32_32x32x16_bf16 v[64:79], v[176:179], v[148:151], v[64:79]
    ds_read_b64_tr_b16 v[176:176+1], v204 offset:24576
    ds_read_b64_tr_b16 v[178:178+1], v204 offset:25600
    s_waitcnt lgkmcnt(6)
    v_mfma_f32_32x32x16_bf16 v[80:95], v[180:183], v[148:151], v[80:95]
    ds_read_b64_tr_b16 v[180:180+1], v205 offset:24576
    ds_read_b64_tr_b16 v[182:182+1], v205 offset:25600
    s_waitcnt lgkmcnt(6)
    v_mfma_f32_32x32x16_bf16 v[96:111], v[184:187], v[148:151], v[96:111]
    ds_read_b64_tr_b16 v[184:184+1], v206 offset:24576
    ds_read_b64_tr_b16 v[186:186+1], v206 offset:25600
    s_waitcnt lgkmcnt(6)
    v_mfma_f32_32x32x16_bf16 v[112:127], v[188:191], v[148:151], v[112:127]
    ds_read_b64_tr_b16 v[188:188+1], v207 offset:24576
    ds_read_b64_tr_b16 v[190:190+1], v207 offset:25600
    s_waitcnt lgkmcnt(6)
    v_mfma_f32_32x32x16_bf16 v[64:79], v[176:179], v[152:155], v[64:79]
    ds_read_b64_tr_b16 v[176:176+1], v204 offset:28672
    ds_read_b64_tr_b16 v[178:178+1], v204 offset:29696
    s_waitcnt lgkmcnt(6)
    v_mfma_f32_32x32x16_bf16 v[80:95], v[180:183], v[152:155], v[80:95]
    ds_read_b64_tr_b16 v[180:180+1], v205 offset:28672
    ds_read_b64_tr_b16 v[182:182+1], v205 offset:29696
    s_waitcnt lgkmcnt(6)
    v_mfma_f32_32x32x16_bf16 v[96:111], v[184:187], v[152:155], v[96:111]
    ds_read_b64_tr_b16 v[184:184+1], v206 offset:28672
    ds_read_b64_tr_b16 v[186:186+1], v206 offset:29696
    s_waitcnt lgkmcnt(6)
    v_mfma_f32_32x32x16_bf16 v[112:127], v[188:191], v[152:155], v[112:127]
    ds_read_b64_tr_b16 v[188:188+1], v207 offset:28672
    ds_read_b64_tr_b16 v[190:190+1], v207 offset:29696
    s_waitcnt lgkmcnt(6)
    v_mfma_f32_32x32x16_bf16 v[64:79], v[176:179], v[156:159], v[64:79]
    s_waitcnt lgkmcnt(4)
    v_mfma_f32_32x32x16_bf16 v[80:95], v[180:183], v[156:159], v[80:95]
    s_waitcnt lgkmcnt(2)
    v_mfma_f32_32x32x16_bf16 v[96:111], v[184:187], v[156:159], v[96:111]
    s_waitcnt lgkmcnt(0)
    v_mfma_f32_32x32x16_bf16 v[112:127], v[188:191], v[156:159], v[112:127]
    s_waitcnt vmcnt(20)
    s_barrier
    buffer_load_dwordx4 v[144:147], v208, s[20:23], 0 offen offset:384
    buffer_load_dwordx4 v[148:151], v208, s[20:23], 0 offen offset:416
    buffer_load_dwordx4 v[152:155], v208, s[20:23], 0 offen offset:448
    buffer_load_dwordx4 v[156:159], v208, s[20:23], 0 offen offset:480
    s_add_u32 m0, s44, 16384
    s_add_u32 s40, s45, 2621440
    buffer_load_dwordx4 v221, s[32:35], s40 offen offset:0 lds
    s_add_u32 s40, s45, 2653184
    buffer_load_dwordx4 v221, s[32:35], s40 offen offset:1024 lds
    s_add_u32 s40, s45, 2684928
    buffer_load_dwordx4 v221, s[32:35], s40 offen offset:2048 lds
    s_add_u32 s40, s45, 2716672
    buffer_load_dwordx4 v221, s[32:35], s40 offen offset:3072 lds
    s_waitcnt vmcnt(12)
    ds_read_b64_tr_b16 v[176:176+1], v204 offset:32768
    ds_read_b64_tr_b16 v[178:178+1], v204 offset:33792
    ds_read_b64_tr_b16 v[180:180+1], v205 offset:32768
    ds_read_b64_tr_b16 v[182:182+1], v205 offset:33792
    ds_read_b64_tr_b16 v[184:184+1], v206 offset:32768
    ds_read_b64_tr_b16 v[186:186+1], v206 offset:33792
    ds_read_b64_tr_b16 v[188:188+1], v207 offset:32768
    ds_read_b64_tr_b16 v[190:190+1], v207 offset:33792
    s_waitcnt lgkmcnt(6)
    v_mfma_f32_32x32x16_bf16 v[64:79], v[176:179], v[128:131], v[64:79]
    ds_read_b64_tr_b16 v[176:176+1], v204 offset:36864
    ds_read_b64_tr_b16 v[178:178+1], v204 offset:37888
    s_waitcnt lgkmcnt(6)
    v_mfma_f32_32x32x16_bf16 v[80:95], v[180:183], v[128:131], v[80:95]
    ds_read_b64_tr_b16 v[180:180+1], v205 offset:36864
    ds_read_b64_tr_b16 v[182:182+1], v205 offset:37888
    s_waitcnt lgkmcnt(6)
    v_mfma_f32_32x32x16_bf16 v[96:111], v[184:187], v[128:131], v[96:111]
    ds_read_b64_tr_b16 v[184:184+1], v206 offset:36864
    ds_read_b64_tr_b16 v[186:186+1], v206 offset:37888
    s_waitcnt lgkmcnt(6)
    v_mfma_f32_32x32x16_bf16 v[112:127], v[188:191], v[128:131], v[112:127]
    ds_read_b64_tr_b16 v[188:188+1], v207 offset:36864
    ds_read_b64_tr_b16 v[190:190+1], v207 offset:37888
    s_waitcnt lgkmcnt(6)
    v_mfma_f32_32x32x16_bf16 v[64:79], v[176:179], v[132:135], v[64:79]
    ds_read_b64_tr_b16 v[176:176+1], v204 offset:40960
    ds_read_b64_tr_b16 v[178:178+1], v204 offset:41984
    s_waitcnt lgkmcnt(6)
    v_mfma_f32_32x32x16_bf16 v[80:95], v[180:183], v[132:135], v[80:95]
    ds_read_b64_tr_b16 v[180:180+1], v205 offset:40960
    ds_read_b64_tr_b16 v[182:182+1], v205 offset:41984
    s_waitcnt lgkmcnt(6)
    v_mfma_f32_32x32x16_bf16 v[96:111], v[184:187], v[132:135], v[96:111]
    ds_read_b64_tr_b16 v[184:184+1], v206 offset:40960
    ds_read_b64_tr_b16 v[186:186+1], v206 offset:41984
    s_waitcnt lgkmcnt(6)
    v_mfma_f32_32x32x16_bf16 v[112:127], v[188:191], v[132:135], v[112:127]
    ds_read_b64_tr_b16 v[188:188+1], v207 offset:40960
    ds_read_b64_tr_b16 v[190:190+1], v207 offset:41984
    s_waitcnt lgkmcnt(6)
    v_mfma_f32_32x32x16_bf16 v[64:79], v[176:179], v[136:139], v[64:79]
    ds_read_b64_tr_b16 v[176:176+1], v204 offset:45056
    ds_read_b64_tr_b16 v[178:178+1], v204 offset:46080
    s_waitcnt lgkmcnt(6)
    v_mfma_f32_32x32x16_bf16 v[80:95], v[180:183], v[136:139], v[80:95]
    ds_read_b64_tr_b16 v[180:180+1], v205 offset:45056
    ds_read_b64_tr_b16 v[182:182+1], v205 offset:46080
    s_waitcnt lgkmcnt(6)
    v_mfma_f32_32x32x16_bf16 v[96:111], v[184:187], v[136:139], v[96:111]
    ds_read_b64_tr_b16 v[184:184+1], v206 offset:45056
    ds_read_b64_tr_b16 v[186:186+1], v206 offset:46080
    s_waitcnt lgkmcnt(6)
    v_mfma_f32_32x32x16_bf16 v[112:127], v[188:191], v[136:139], v[112:127]
    ds_read_b64_tr_b16 v[188:188+1], v207 offset:45056
    ds_read_b64_tr_b16 v[190:190+1], v207 offset:46080
    s_waitcnt lgkmcnt(6)
    v_mfma_f32_32x32x16_bf16 v[64:79], v[176:179], v[140:143], v[64:79]
    s_waitcnt lgkmcnt(4)
    v_mfma_f32_32x32x16_bf16 v[80:95], v[180:183], v[140:143], v[80:95]
    s_waitcnt lgkmcnt(2)
    v_mfma_f32_32x32x16_bf16 v[96:111], v[184:187], v[140:143], v[96:111]
    s_waitcnt lgkmcnt(0)
    v_mfma_f32_32x32x16_bf16 v[112:127], v[188:191], v[140:143], v[112:127]
    s_waitcnt vmcnt(16)
    s_barrier
    buffer_load_dwordx4 v[128:131], v208, s[20:23], 0 offen offset:512
    buffer_load_dwordx4 v[132:135], v208, s[20:23], 0 offen offset:544
    buffer_load_dwordx4 v[136:139], v208, s[20:23], 0 offen offset:576
    buffer_load_dwordx4 v[140:143], v208, s[20:23], 0 offen offset:608
    s_add_u32 m0, s44, 32768
    s_add_u32 s40, s45, 3145728
    buffer_load_dwordx4 v221, s[32:35], s40 offen offset:0 lds
    s_add_u32 s40, s45, 3177472
    buffer_load_dwordx4 v221, s[32:35], s40 offen offset:1024 lds
    s_add_u32 s40, s45, 3209216
    buffer_load_dwordx4 v221, s[32:35], s40 offen offset:2048 lds
    s_add_u32 s40, s45, 3240960
    buffer_load_dwordx4 v221, s[32:35], s40 offen offset:3072 lds
    s_waitcnt vmcnt(12)
    ds_read_b64_tr_b16 v[176:176+1], v204 offset:49152
    ds_read_b64_tr_b16 v[178:178+1], v204 offset:50176
    ds_read_b64_tr_b16 v[180:180+1], v205 offset:49152
    ds_read_b64_tr_b16 v[182:182+1], v205 offset:50176
    ds_read_b64_tr_b16 v[184:184+1], v206 offset:49152
    ds_read_b64_tr_b16 v[186:186+1], v206 offset:50176
    ds_read_b64_tr_b16 v[188:188+1], v207 offset:49152
    ds_read_b64_tr_b16 v[190:190+1], v207 offset:50176
    s_waitcnt lgkmcnt(6)
    v_mfma_f32_32x32x16_bf16 v[64:79], v[176:179], v[144:147], v[64:79]
    ds_read_b64_tr_b16 v[176:176+1], v204 offset:53248
    ds_read_b64_tr_b16 v[178:178+1], v204 offset:54272
    s_waitcnt lgkmcnt(6)
    v_mfma_f32_32x32x16_bf16 v[80:95], v[180:183], v[144:147], v[80:95]
    ds_read_b64_tr_b16 v[180:180+1], v205 offset:53248
    ds_read_b64_tr_b16 v[182:182+1], v205 offset:54272
    s_waitcnt lgkmcnt(6)
    v_mfma_f32_32x32x16_bf16 v[96:111], v[184:187], v[144:147], v[96:111]
    ds_read_b64_tr_b16 v[184:184+1], v206 offset:53248
    ds_read_b64_tr_b16 v[186:186+1], v206 offset:54272
    s_waitcnt lgkmcnt(6)
    v_mfma_f32_32x32x16_bf16 v[112:127], v[188:191], v[144:147], v[112:127]
    ds_read_b64_tr_b16 v[188:188+1], v207 offset:53248
    ds_read_b64_tr_b16 v[190:190+1], v207 offset:54272
    s_waitcnt lgkmcnt(6)
    v_mfma_f32_32x32x16_bf16 v[64:79], v[176:179], v[148:151], v[64:79]
    ds_read_b64_tr_b16 v[176:176+1], v204 offset:57344
    ds_read_b64_tr_b16 v[178:178+1], v204 offset:58368
    s_waitcnt lgkmcnt(6)
    v_mfma_f32_32x32x16_bf16 v[80:95], v[180:183], v[148:151], v[80:95]
    ds_read_b64_tr_b16 v[180:180+1], v205 offset:57344
    ds_read_b64_tr_b16 v[182:182+1], v205 offset:58368
    s_waitcnt lgkmcnt(6)
    v_mfma_f32_32x32x16_bf16 v[96:111], v[184:187], v[148:151], v[96:111]
    ds_read_b64_tr_b16 v[184:184+1], v206 offset:57344
    ds_read_b64_tr_b16 v[186:186+1], v206 offset:58368
    s_waitcnt lgkmcnt(6)
    v_mfma_f32_32x32x16_bf16 v[112:127], v[188:191], v[148:151], v[112:127]
    ds_read_b64_tr_b16 v[188:188+1], v207 offset:57344
    ds_read_b64_tr_b16 v[190:190+1], v207 offset:58368
    s_waitcnt lgkmcnt(6)
    v_mfma_f32_32x32x16_bf16 v[64:79], v[176:179], v[152:155], v[64:79]
    ds_read_b64_tr_b16 v[176:176+1], v204 offset:61440
    ds_read_b64_tr_b16 v[178:178+1], v204 offset:62464
    s_waitcnt lgkmcnt(6)
    v_mfma_f32_32x32x16_bf16 v[80:95], v[180:183], v[152:155], v[80:95]
    ds_read_b64_tr_b16 v[180:180+1], v205 offset:61440
    ds_read_b64_tr_b16 v[182:182+1], v205 offset:62464
    s_waitcnt lgkmcnt(6)
    v_mfma_f32_32x32x16_bf16 v[96:111], v[184:187], v[152:155], v[96:111]
    ds_read_b64_tr_b16 v[184:184+1], v206 offset:61440
    ds_read_b64_tr_b16 v[186:186+1], v206 offset:62464
    s_waitcnt lgkmcnt(6)
    v_mfma_f32_32x32x16_bf16 v[112:127], v[188:191], v[152:155], v[112:127]
    ds_read_b64_tr_b16 v[188:188+1], v207 offset:61440
    ds_read_b64_tr_b16 v[190:190+1], v207 offset:62464
    s_waitcnt lgkmcnt(6)
    v_mfma_f32_32x32x16_bf16 v[64:79], v[176:179], v[156:159], v[64:79]
    s_waitcnt lgkmcnt(4)
    v_mfma_f32_32x32x16_bf16 v[80:95], v[180:183], v[156:159], v[80:95]
    s_waitcnt lgkmcnt(2)
    v_mfma_f32_32x32x16_bf16 v[96:111], v[184:187], v[156:159], v[96:111]
    s_waitcnt lgkmcnt(0)
    v_mfma_f32_32x32x16_bf16 v[112:127], v[188:191], v[156:159], v[112:127]
    s_waitcnt vmcnt(16)
    s_barrier
    buffer_load_dwordx4 v[144:147], v208, s[20:23], 0 offen offset:640
    buffer_load_dwordx4 v[148:151], v208, s[20:23], 0 offen offset:672
    buffer_load_dwordx4 v[152:155], v208, s[20:23], 0 offen offset:704
    buffer_load_dwordx4 v[156:159], v208, s[20:23], 0 offen offset:736
    s_add_u32 m0, s44, 49152
    s_add_u32 s40, s45, 3670016
    buffer_load_dwordx4 v221, s[32:35], s40 offen offset:0 lds
    s_add_u32 s40, s45, 3701760
    buffer_load_dwordx4 v221, s[32:35], s40 offen offset:1024 lds
    s_add_u32 s40, s45, 3733504
    buffer_load_dwordx4 v221, s[32:35], s40 offen offset:2048 lds
    s_add_u32 s40, s45, 3765248
    buffer_load_dwordx4 v221, s[32:35], s40 offen offset:3072 lds
    s_waitcnt vmcnt(12)
    ds_read_b64_tr_b16 v[176:176+1], v204 offset:0
    ds_read_b64_tr_b16 v[178:178+1], v204 offset:1024
    ds_read_b64_tr_b16 v[180:180+1], v205 offset:0
    ds_read_b64_tr_b16 v[182:182+1], v205 offset:1024
    ds_read_b64_tr_b16 v[184:184+1], v206 offset:0
    ds_read_b64_tr_b16 v[186:186+1], v206 offset:1024
    ds_read_b64_tr_b16 v[188:188+1], v207 offset:0
    ds_read_b64_tr_b16 v[190:190+1], v207 offset:1024
    s_waitcnt lgkmcnt(6)
    v_mfma_f32_32x32x16_bf16 v[64:79], v[176:179], v[128:131], v[64:79]
    ds_read_b64_tr_b16 v[176:176+1], v204 offset:4096
    ds_read_b64_tr_b16 v[178:178+1], v204 offset:5120
    s_waitcnt lgkmcnt(6)
    v_mfma_f32_32x32x16_bf16 v[80:95], v[180:183], v[128:131], v[80:95]
    ds_read_b64_tr_b16 v[180:180+1], v205 offset:4096
    ds_read_b64_tr_b16 v[182:182+1], v205 offset:5120
    s_waitcnt lgkmcnt(6)
    v_mfma_f32_32x32x16_bf16 v[96:111], v[184:187], v[128:131], v[96:111]
    ds_read_b64_tr_b16 v[184:184+1], v206 offset:4096
    ds_read_b64_tr_b16 v[186:186+1], v206 offset:5120
    s_waitcnt lgkmcnt(6)
    v_mfma_f32_32x32x16_bf16 v[112:127], v[188:191], v[128:131], v[112:127]
    ds_read_b64_tr_b16 v[188:188+1], v207 offset:4096
    ds_read_b64_tr_b16 v[190:190+1], v207 offset:5120
    s_waitcnt lgkmcnt(6)
    v_mfma_f32_32x32x16_bf16 v[64:79], v[176:179], v[132:135], v[64:79]
    ds_read_b64_tr_b16 v[176:176+1], v204 offset:8192
    ds_read_b64_tr_b16 v[178:178+1], v204 offset:9216
    s_waitcnt lgkmcnt(6)
    v_mfma_f32_32x32x16_bf16 v[80:95], v[180:183], v[132:135], v[80:95]
    ds_read_b64_tr_b16 v[180:180+1], v205 offset:8192
    ds_read_b64_tr_b16 v[182:182+1], v205 offset:9216
    s_waitcnt lgkmcnt(6)
    v_mfma_f32_32x32x16_bf16 v[96:111], v[184:187], v[132:135], v[96:111]
    ds_read_b64_tr_b16 v[184:184+1], v206 offset:8192
    ds_read_b64_tr_b16 v[186:186+1], v206 offset:9216
    s_waitcnt lgkmcnt(6)
    v_mfma_f32_32x32x16_bf16 v[112:127], v[188:191], v[132:135], v[112:127]
    ds_read_b64_tr_b16 v[188:188+1], v207 offset:8192
    ds_read_b64_tr_b16 v[190:190+1], v207 offset:9216
    s_waitcnt lgkmcnt(6)
    v_mfma_f32_32x32x16_bf16 v[64:79], v[176:179], v[136:139], v[64:79]
    ds_read_b64_tr_b16 v[176:176+1], v204 offset:12288
    ds_read_b64_tr_b16 v[178:178+1], v204 offset:13312
    s_waitcnt lgkmcnt(6)
    v_mfma_f32_32x32x16_bf16 v[80:95], v[180:183], v[136:139], v[80:95]
    ds_read_b64_tr_b16 v[180:180+1], v205 offset:12288
    ds_read_b64_tr_b16 v[182:182+1], v205 offset:13312
    s_waitcnt lgkmcnt(6)
    v_mfma_f32_32x32x16_bf16 v[96:111], v[184:187], v[136:139], v[96:111]
    ds_read_b64_tr_b16 v[184:184+1], v206 offset:12288
    ds_read_b64_tr_b16 v[186:186+1], v206 offset:13312
    s_waitcnt lgkmcnt(6)
    v_mfma_f32_32x32x16_bf16 v[112:127], v[188:191], v[136:139], v[112:127]
    ds_read_b64_tr_b16 v[188:188+1], v207 offset:12288
    ds_read_b64_tr_b16 v[190:190+1], v207 offset:13312
    s_waitcnt lgkmcnt(6)
    v_mfma_f32_32x32x16_bf16 v[64:79], v[176:179], v[140:143], v[64:79]
    s_waitcnt lgkmcnt(4)
    v_mfma_f32_32x32x16_bf16 v[80:95], v[180:183], v[140:143], v[80:95]
    s_waitcnt lgkmcnt(2)
    v_mfma_f32_32x32x16_bf16 v[96:111], v[184:187], v[140:143], v[96:111]
    s_waitcnt lgkmcnt(0)
    v_mfma_f32_32x32x16_bf16 v[112:127], v[188:191], v[140:143], v[112:127]
    s_waitcnt vmcnt(16)
    s_barrier
    buffer_load_dwordx4 v[128:131], v208, s[20:23], 0 offen offset:768
    buffer_load_dwordx4 v[132:135], v208, s[20:23], 0 offen offset:800
    buffer_load_dwordx4 v[136:139], v208, s[20:23], 0 offen offset:832
    buffer_load_dwordx4 v[140:143], v208, s[20:23], 0 offen offset:864
    s_add_u32 m0, s44, 0
    s_add_u32 s41, s2, 0
    s_and_b32 s41, s41, 7
    s_lshl_b32 s41, s41, 14
    s_add_u32 s40, s41, s44
    buffer_load_dwordx4 v216, s[24:27], s40 offen offset:0 lds
    s_add_u32 s41, s2, 0
    s_and_b32 s41, s41, 7
    s_lshl_b32 s41, s41, 14
    s_add_u32 s40, s41, s44
    buffer_load_dwordx4 v217, s[24:27], s40 offen offset:1024 lds
    s_add_u32 s41, s2, 0
    s_and_b32 s41, s41, 7
    s_lshl_b32 s41, s41, 14
    s_add_u32 s40, s41, s44
    buffer_load_dwordx4 v218, s[24:27], s40 offen offset:2048 lds
    s_add_u32 s41, s2, 0
    s_and_b32 s41, s41, 7
    s_lshl_b32 s41, s41, 14
    s_add_u32 s40, s41, s44
    buffer_load_dwordx4 v219, s[24:27], s40 offen offset:3072 lds
    s_waitcnt vmcnt(12)
    ds_read_b64_tr_b16 v[176:176+1], v204 offset:16384
    ds_read_b64_tr_b16 v[178:178+1], v204 offset:17408
    ds_read_b64_tr_b16 v[180:180+1], v205 offset:16384
    ds_read_b64_tr_b16 v[182:182+1], v205 offset:17408
    ds_read_b64_tr_b16 v[184:184+1], v206 offset:16384
    ds_read_b64_tr_b16 v[186:186+1], v206 offset:17408
    ds_read_b64_tr_b16 v[188:188+1], v207 offset:16384
    ds_read_b64_tr_b16 v[190:190+1], v207 offset:17408
    s_waitcnt lgkmcnt(6)
    v_mfma_f32_32x32x16_bf16 v[64:79], v[176:179], v[144:147], v[64:79]
    ds_read_b64_tr_b16 v[176:176+1], v204 offset:20480
    ds_read_b64_tr_b16 v[178:178+1], v204 offset:21504
    s_waitcnt lgkmcnt(6)
    v_mfma_f32_32x32x16_bf16 v[80:95], v[180:183], v[144:147], v[80:95]
    ds_read_b64_tr_b16 v[180:180+1], v205 offset:20480
    ds_read_b64_tr_b16 v[182:182+1], v205 offset:21504
    s_waitcnt lgkmcnt(6)
    v_mfma_f32_32x32x16_bf16 v[96:111], v[184:187], v[144:147], v[96:111]
    ds_read_b64_tr_b16 v[184:184+1], v206 offset:20480
    ds_read_b64_tr_b16 v[186:186+1], v206 offset:21504
    s_waitcnt lgkmcnt(6)
    v_mfma_f32_32x32x16_bf16 v[112:127], v[188:191], v[144:147], v[112:127]
    ds_read_b64_tr_b16 v[188:188+1], v207 offset:20480
    ds_read_b64_tr_b16 v[190:190+1], v207 offset:21504
    s_waitcnt lgkmcnt(6)
    v_mfma_f32_32x32x16_bf16 v[64:79], v[176:179], v[148:151], v[64:79]
    ds_read_b64_tr_b16 v[176:176+1], v204 offset:24576
    ds_read_b64_tr_b16 v[178:178+1], v204 offset:25600
    s_waitcnt lgkmcnt(6)
    v_mfma_f32_32x32x16_bf16 v[80:95], v[180:183], v[148:151], v[80:95]
    ds_read_b64_tr_b16 v[180:180+1], v205 offset:24576
    ds_read_b64_tr_b16 v[182:182+1], v205 offset:25600
    s_waitcnt lgkmcnt(6)
    v_mfma_f32_32x32x16_bf16 v[96:111], v[184:187], v[148:151], v[96:111]
    ds_read_b64_tr_b16 v[184:184+1], v206 offset:24576
    ds_read_b64_tr_b16 v[186:186+1], v206 offset:25600
    s_waitcnt lgkmcnt(6)
    v_mfma_f32_32x32x16_bf16 v[112:127], v[188:191], v[148:151], v[112:127]
    ds_read_b64_tr_b16 v[188:188+1], v207 offset:24576
    ds_read_b64_tr_b16 v[190:190+1], v207 offset:25600
    s_waitcnt lgkmcnt(6)
    v_mfma_f32_32x32x16_bf16 v[64:79], v[176:179], v[152:155], v[64:79]
    ds_read_b64_tr_b16 v[176:176+1], v204 offset:28672
    ds_read_b64_tr_b16 v[178:178+1], v204 offset:29696
    s_waitcnt lgkmcnt(6)
    v_mfma_f32_32x32x16_bf16 v[80:95], v[180:183], v[152:155], v[80:95]
    ds_read_b64_tr_b16 v[180:180+1], v205 offset:28672
    ds_read_b64_tr_b16 v[182:182+1], v205 offset:29696
    s_waitcnt lgkmcnt(6)
    v_mfma_f32_32x32x16_bf16 v[96:111], v[184:187], v[152:155], v[96:111]
    ds_read_b64_tr_b16 v[184:184+1], v206 offset:28672
    ds_read_b64_tr_b16 v[186:186+1], v206 offset:29696
    s_waitcnt lgkmcnt(6)
    v_mfma_f32_32x32x16_bf16 v[112:127], v[188:191], v[152:155], v[112:127]
    ds_read_b64_tr_b16 v[188:188+1], v207 offset:28672
    ds_read_b64_tr_b16 v[190:190+1], v207 offset:29696
    s_waitcnt lgkmcnt(6)
    v_mfma_f32_32x32x16_bf16 v[64:79], v[176:179], v[156:159], v[64:79]
    s_waitcnt lgkmcnt(4)
    v_mfma_f32_32x32x16_bf16 v[80:95], v[180:183], v[156:159], v[80:95]
    s_waitcnt lgkmcnt(2)
    v_mfma_f32_32x32x16_bf16 v[96:111], v[184:187], v[156:159], v[96:111]
    s_waitcnt lgkmcnt(0)
    v_mfma_f32_32x32x16_bf16 v[112:127], v[188:191], v[156:159], v[112:127]
    s_waitcnt vmcnt(16)
    s_barrier
    buffer_load_dwordx4 v[144:147], v208, s[20:23], 0 offen offset:896
    buffer_load_dwordx4 v[148:151], v208, s[20:23], 0 offen offset:928
    buffer_load_dwordx4 v[152:155], v208, s[20:23], 0 offen offset:960
    buffer_load_dwordx4 v[156:159], v208, s[20:23], 0 offen offset:992
    s_add_u32 m0, s44, 16384
    s_add_u32 s41, s2, 0
    s_and_b32 s41, s41, 7
    s_lshl_b32 s41, s41, 14
    s_add_u32 s40, s41, s44
    buffer_load_dwordx4 v220, s[28:31], s40 offen offset:0 lds
    s_add_u32 s41, s2, 0
    s_and_b32 s41, s41, 7
    s_lshl_b32 s41, s41, 14
    s_add_u32 s40, s41, s44
    buffer_load_dwordx4 v220, s[28:31], s40 offen offset:1024 lds
    s_add_u32 s41, s2, 0
    s_and_b32 s41, s41, 7
    s_lshl_b32 s41, s41, 14
    s_add_u32 s40, s41, s44
    buffer_load_dwordx4 v220, s[28:31], s40 offen offset:2048 lds
    s_add_u32 s41, s2, 0
    s_and_b32 s41, s41, 7
    s_lshl_b32 s41, s41, 14
    s_add_u32 s40, s41, s44
    buffer_load_dwordx4 v220, s[28:31], s40 offen offset:3072 lds
    s_waitcnt vmcnt(12)
    ds_read_b64_tr_b16 v[176:176+1], v204 offset:32768
    ds_read_b64_tr_b16 v[178:178+1], v204 offset:33792
    ds_read_b64_tr_b16 v[180:180+1], v205 offset:32768
    ds_read_b64_tr_b16 v[182:182+1], v205 offset:33792
    ds_read_b64_tr_b16 v[184:184+1], v206 offset:32768
    ds_read_b64_tr_b16 v[186:186+1], v206 offset:33792
    ds_read_b64_tr_b16 v[188:188+1], v207 offset:32768
    ds_read_b64_tr_b16 v[190:190+1], v207 offset:33792
    s_waitcnt lgkmcnt(6)
    v_mfma_f32_32x32x16_bf16 v[64:79], v[176:179], v[128:131], v[64:79]
    ds_read_b64_tr_b16 v[176:176+1], v204 offset:36864
    ds_read_b64_tr_b16 v[178:178+1], v204 offset:37888
    s_waitcnt lgkmcnt(6)
    v_mfma_f32_32x32x16_bf16 v[80:95], v[180:183], v[128:131], v[80:95]
    ds_read_b64_tr_b16 v[180:180+1], v205 offset:36864
    ds_read_b64_tr_b16 v[182:182+1], v205 offset:37888
    s_waitcnt lgkmcnt(6)
    v_mfma_f32_32x32x16_bf16 v[96:111], v[184:187], v[128:131], v[96:111]
    ds_read_b64_tr_b16 v[184:184+1], v206 offset:36864
    ds_read_b64_tr_b16 v[186:186+1], v206 offset:37888
    s_waitcnt lgkmcnt(6)
    v_mfma_f32_32x32x16_bf16 v[112:127], v[188:191], v[128:131], v[112:127]
    ds_read_b64_tr_b16 v[188:188+1], v207 offset:36864
    ds_read_b64_tr_b16 v[190:190+1], v207 offset:37888
    s_waitcnt lgkmcnt(6)
    v_mfma_f32_32x32x16_bf16 v[64:79], v[176:179], v[132:135], v[64:79]
    ds_read_b64_tr_b16 v[176:176+1], v204 offset:40960
    ds_read_b64_tr_b16 v[178:178+1], v204 offset:41984
    s_waitcnt lgkmcnt(6)
    v_mfma_f32_32x32x16_bf16 v[80:95], v[180:183], v[132:135], v[80:95]
    ds_read_b64_tr_b16 v[180:180+1], v205 offset:40960
    ds_read_b64_tr_b16 v[182:182+1], v205 offset:41984
    s_waitcnt lgkmcnt(6)
    v_mfma_f32_32x32x16_bf16 v[96:111], v[184:187], v[132:135], v[96:111]
    ds_read_b64_tr_b16 v[184:184+1], v206 offset:40960
    ds_read_b64_tr_b16 v[186:186+1], v206 offset:41984
    s_waitcnt lgkmcnt(6)
    v_mfma_f32_32x32x16_bf16 v[112:127], v[188:191], v[132:135], v[112:127]
    ds_read_b64_tr_b16 v[188:188+1], v207 offset:40960
    ds_read_b64_tr_b16 v[190:190+1], v207 offset:41984
    s_waitcnt lgkmcnt(6)
    v_mfma_f32_32x32x16_bf16 v[64:79], v[176:179], v[136:139], v[64:79]
    ds_read_b64_tr_b16 v[176:176+1], v204 offset:45056
    ds_read_b64_tr_b16 v[178:178+1], v204 offset:46080
    s_waitcnt lgkmcnt(6)
    v_mfma_f32_32x32x16_bf16 v[80:95], v[180:183], v[136:139], v[80:95]
    ds_read_b64_tr_b16 v[180:180+1], v205 offset:45056
    ds_read_b64_tr_b16 v[182:182+1], v205 offset:46080
    s_waitcnt lgkmcnt(6)
    v_mfma_f32_32x32x16_bf16 v[96:111], v[184:187], v[136:139], v[96:111]
    ds_read_b64_tr_b16 v[184:184+1], v206 offset:45056
    ds_read_b64_tr_b16 v[186:186+1], v206 offset:46080
    s_waitcnt lgkmcnt(6)
    v_mfma_f32_32x32x16_bf16 v[112:127], v[188:191], v[136:139], v[112:127]
    ds_read_b64_tr_b16 v[188:188+1], v207 offset:45056
    ds_read_b64_tr_b16 v[190:190+1], v207 offset:46080
    s_waitcnt lgkmcnt(6)
    v_mfma_f32_32x32x16_bf16 v[64:79], v[176:179], v[140:143], v[64:79]
    s_waitcnt lgkmcnt(4)
    v_mfma_f32_32x32x16_bf16 v[80:95], v[180:183], v[140:143], v[80:95]
    s_waitcnt lgkmcnt(2)
    v_mfma_f32_32x32x16_bf16 v[96:111], v[184:187], v[140:143], v[96:111]
    s_waitcnt lgkmcnt(0)
    v_mfma_f32_32x32x16_bf16 v[112:127], v[188:191], v[140:143], v[112:127]
    s_waitcnt vmcnt(16)
    s_barrier
    s_add_u32 m0, s44, 32768
    s_add_u32 s41, s2, 1
    s_and_b32 s41, s41, 7
    s_lshl_b32 s41, s41, 14
    s_add_u32 s40, s41, s44
    buffer_load_dwordx4 v216, s[24:27], s40 offen offset:0 lds
    s_add_u32 s41, s2, 1
    s_and_b32 s41, s41, 7
    s_lshl_b32 s41, s41, 14
    s_add_u32 s40, s41, s44
    buffer_load_dwordx4 v217, s[24:27], s40 offen offset:1024 lds
    s_add_u32 s41, s2, 1
    s_and_b32 s41, s41, 7
    s_lshl_b32 s41, s41, 14
    s_add_u32 s40, s41, s44
    buffer_load_dwordx4 v218, s[24:27], s40 offen offset:2048 lds
    s_add_u32 s41, s2, 1
    s_and_b32 s41, s41, 7
    s_lshl_b32 s41, s41, 14
    s_add_u32 s40, s41, s44
    buffer_load_dwordx4 v219, s[24:27], s40 offen offset:3072 lds
    s_waitcnt vmcnt(8)
    ds_read_b64_tr_b16 v[176:176+1], v204 offset:49152
    ds_read_b64_tr_b16 v[178:178+1], v204 offset:50176
    ds_read_b64_tr_b16 v[180:180+1], v205 offset:49152
    ds_read_b64_tr_b16 v[182:182+1], v205 offset:50176
    ds_read_b64_tr_b16 v[184:184+1], v206 offset:49152
    ds_read_b64_tr_b16 v[186:186+1], v206 offset:50176
    ds_read_b64_tr_b16 v[188:188+1], v207 offset:49152
    ds_read_b64_tr_b16 v[190:190+1], v207 offset:50176
    s_waitcnt lgkmcnt(6)
    v_mfma_f32_32x32x16_bf16 v[64:79], v[176:179], v[144:147], v[64:79]
    ds_read_b64_tr_b16 v[176:176+1], v204 offset:53248
    ds_read_b64_tr_b16 v[178:178+1], v204 offset:54272
    s_waitcnt lgkmcnt(6)
    v_mfma_f32_32x32x16_bf16 v[80:95], v[180:183], v[144:147], v[80:95]
    ds_read_b64_tr_b16 v[180:180+1], v205 offset:53248
    ds_read_b64_tr_b16 v[182:182+1], v205 offset:54272
    s_waitcnt lgkmcnt(6)
    v_mfma_f32_32x32x16_bf16 v[96:111], v[184:187], v[144:147], v[96:111]
    ds_read_b64_tr_b16 v[184:184+1], v206 offset:53248
    ds_read_b64_tr_b16 v[186:186+1], v206 offset:54272
    s_waitcnt lgkmcnt(6)
    v_mfma_f32_32x32x16_bf16 v[112:127], v[188:191], v[144:147], v[112:127]
    ds_read_b64_tr_b16 v[188:188+1], v207 offset:53248
    ds_read_b64_tr_b16 v[190:190+1], v207 offset:54272
    s_waitcnt lgkmcnt(6)
    v_mfma_f32_32x32x16_bf16 v[64:79], v[176:179], v[148:151], v[64:79]
    ds_read_b64_tr_b16 v[176:176+1], v204 offset:57344
    ds_read_b64_tr_b16 v[178:178+1], v204 offset:58368
    s_waitcnt lgkmcnt(6)
    v_mfma_f32_32x32x16_bf16 v[80:95], v[180:183], v[148:151], v[80:95]
    ds_read_b64_tr_b16 v[180:180+1], v205 offset:57344
    ds_read_b64_tr_b16 v[182:182+1], v205 offset:58368
    s_waitcnt lgkmcnt(6)
    v_mfma_f32_32x32x16_bf16 v[96:111], v[184:187], v[148:151], v[96:111]
    ds_read_b64_tr_b16 v[184:184+1], v206 offset:57344
    ds_read_b64_tr_b16 v[186:186+1], v206 offset:58368
    s_waitcnt lgkmcnt(6)
    v_mfma_f32_32x32x16_bf16 v[112:127], v[188:191], v[148:151], v[112:127]
    ds_read_b64_tr_b16 v[188:188+1], v207 offset:57344
    ds_read_b64_tr_b16 v[190:190+1], v207 offset:58368
    s_waitcnt lgkmcnt(6)
    v_mfma_f32_32x32x16_bf16 v[64:79], v[176:179], v[152:155], v[64:79]
    ds_read_b64_tr_b16 v[176:176+1], v204 offset:61440
    ds_read_b64_tr_b16 v[178:178+1], v204 offset:62464
    s_waitcnt lgkmcnt(6)
    v_mfma_f32_32x32x16_bf16 v[80:95], v[180:183], v[152:155], v[80:95]
    ds_read_b64_tr_b16 v[180:180+1], v205 offset:61440
    ds_read_b64_tr_b16 v[182:182+1], v205 offset:62464
    s_waitcnt lgkmcnt(6)
    v_mfma_f32_32x32x16_bf16 v[96:111], v[184:187], v[152:155], v[96:111]
    ds_read_b64_tr_b16 v[184:184+1], v206 offset:61440
    ds_read_b64_tr_b16 v[186:186+1], v206 offset:62464
    s_waitcnt lgkmcnt(6)
    v_mfma_f32_32x32x16_bf16 v[112:127], v[188:191], v[152:155], v[112:127]
    ds_read_b64_tr_b16 v[188:188+1], v207 offset:61440
    ds_read_b64_tr_b16 v[190:190+1], v207 offset:62464
    s_waitcnt lgkmcnt(6)
    v_mfma_f32_32x32x16_bf16 v[64:79], v[176:179], v[156:159], v[64:79]
    s_waitcnt lgkmcnt(4)
    v_mfma_f32_32x32x16_bf16 v[80:95], v[180:183], v[156:159], v[80:95]
    s_waitcnt lgkmcnt(2)
    v_mfma_f32_32x32x16_bf16 v[96:111], v[184:187], v[156:159], v[96:111]
    s_waitcnt lgkmcnt(0)
    v_mfma_f32_32x32x16_bf16 v[112:127], v[188:191], v[156:159], v[112:127]
    s_nop 7
    s_nop 4
    s_mov_b32 s40, 1040356334
    v_mul_f32 v64, s40, v64
    v_mul_f32 v65, s40, v65
    v_mul_f32 v66, s40, v66
    v_mul_f32 v67, s40, v67
    v_mul_f32 v68, s40, v68
    v_mul_f32 v69, s40, v69
    v_mul_f32 v70, s40, v70
    v_mul_f32 v71, s40, v71
    v_mul_f32 v72, s40, v72
    v_mul_f32 v73, s40, v73
    v_mul_f32 v74, s40, v74
    v_mul_f32 v75, s40, v75
    v_mul_f32 v76, s40, v76
    v_mul_f32 v77, s40, v77
    v_mul_f32 v78, s40, v78
    v_mul_f32 v79, s40, v79
    v_mul_f32 v80, s40, v80
    v_mul_f32 v81, s40, v81
    v_mul_f32 v82, s40, v82
    v_mul_f32 v83, s40, v83
    v_mul_f32 v84, s40, v84
    v_mul_f32 v85, s40, v85
    v_mul_f32 v86, s40, v86
    v_mul_f32 v87, s40, v87
    v_mul_f32 v88, s40, v88
    v_mul_f32 v89, s40, v89
    v_mul_f32 v90, s40, v90
    v_mul_f32 v91, s40, v91
    v_mul_f32 v92, s40, v92
    v_mul_f32 v93, s40, v93
    v_mul_f32 v94, s40, v94
    v_mul_f32 v95, s40, v95
    v_mul_f32 v96, s40, v96
    v_mul_f32 v97, s40, v97
    v_mul_f32 v98, s40, v98
    v_mul_f32 v99, s40, v99
    v_mul_f32 v100, s40, v100
    v_mul_f32 v101, s40, v101
    v_mul_f32 v102, s40, v102
    v_mul_f32 v103, s40, v103
    v_mul_f32 v104, s40, v104
    v_mul_f32 v105, s40, v105
    v_mul_f32 v106, s40, v106
    v_mul_f32 v107, s40, v107
    v_mul_f32 v108, s40, v108
    v_mul_f32 v109, s40, v109
    v_mul_f32 v110, s40, v110
    v_mul_f32 v111, s40, v111
    v_mul_f32 v112, s40, v112
    v_mul_f32 v113, s40, v113
    v_mul_f32 v114, s40, v114
    v_mul_f32 v115, s40, v115
    v_mul_f32 v116, s40, v116
    v_mul_f32 v117, s40, v117
    v_mul_f32 v118, s40, v118
    v_mul_f32 v119, s40, v119
    v_mul_f32 v120, s40, v120
    v_mul_f32 v121, s40, v121
    v_mul_f32 v122, s40, v122
    v_mul_f32 v123, s40, v123
    v_mul_f32 v124, s40, v124
    v_mul_f32 v125, s40, v125
    v_mul_f32 v126, s40, v126
    v_mul_f32 v127, s40, v127
    v_cvt_pk_bf16_f32 v32, v64, v65
    v_cvt_pk_bf16_f32 v33, v66, v67
    v_cvt_pk_bf16_f32 v34, v68, v69
    v_cvt_pk_bf16_f32 v35, v70, v71
    v_cvt_pk_bf16_f32 v36, v72, v73
    v_cvt_pk_bf16_f32 v37, v74, v75
    v_cvt_pk_bf16_f32 v38, v76, v77
    v_cvt_pk_bf16_f32 v39, v78, v79
    v_cvt_pk_bf16_f32 v40, v80, v81
    v_cvt_pk_bf16_f32 v41, v82, v83
    v_cvt_pk_bf16_f32 v42, v84, v85
    v_cvt_pk_bf16_f32 v43, v86, v87
    v_cvt_pk_bf16_f32 v44, v88, v89
    v_cvt_pk_bf16_f32 v45, v90, v91
    v_cvt_pk_bf16_f32 v46, v92, v93
    v_cvt_pk_bf16_f32 v47, v94, v95
    v_cvt_pk_bf16_f32 v48, v96, v97
    v_cvt_pk_bf16_f32 v49, v98, v99
    v_cvt_pk_bf16_f32 v50, v100, v101
    v_cvt_pk_bf16_f32 v51, v102, v103
    v_cvt_pk_bf16_f32 v52, v104, v105
    v_cvt_pk_bf16_f32 v53, v106, v107
    v_cvt_pk_bf16_f32 v54, v108, v109
    v_cvt_pk_bf16_f32 v55, v110, v111
    v_cvt_pk_bf16_f32 v56, v112, v113
    v_cvt_pk_bf16_f32 v57, v114, v115
    v_cvt_pk_bf16_f32 v58, v116, v117
    v_cvt_pk_bf16_f32 v59, v118, v119
    v_cvt_pk_bf16_f32 v60, v120, v121
    v_cvt_pk_bf16_f32 v61, v122, v123
    v_cvt_pk_bf16_f32 v62, v124, v125
    v_cvt_pk_bf16_f32 v63, v126, v127
    v_mov_b32 v64, 0
    v_mov_b32 v65, 0
    v_mov_b32 v66, 0
    v_mov_b32 v67, 0
    v_mov_b32 v68, 0
    v_mov_b32 v69, 0
    v_mov_b32 v70, 0
    v_mov_b32 v71, 0
    v_mov_b32 v72, 0
    v_mov_b32 v73, 0
    v_mov_b32 v74, 0
    v_mov_b32 v75, 0
    v_mov_b32 v76, 0
    v_mov_b32 v77, 0
    v_mov_b32 v78, 0
    v_mov_b32 v79, 0
    v_mov_b32 v80, 0
    v_mov_b32 v81, 0
    v_mov_b32 v82, 0
    v_mov_b32 v83, 0
    v_mov_b32 v84, 0
    v_mov_b32 v85, 0
    v_mov_b32 v86, 0
    v_mov_b32 v87, 0
    v_mov_b32 v88, 0
    v_mov_b32 v89, 0
    v_mov_b32 v90, 0
    v_mov_b32 v91, 0
    v_mov_b32 v92, 0
    v_mov_b32 v93, 0
    v_mov_b32 v94, 0
    v_mov_b32 v95, 0
    v_mov_b32 v96, 0
    v_mov_b32 v97, 0
    v_mov_b32 v98, 0
    v_mov_b32 v99, 0
    v_mov_b32 v100, 0
    v_mov_b32 v101, 0
    v_mov_b32 v102, 0
    v_mov_b32 v103, 0
    v_mov_b32 v104, 0
    v_mov_b32 v105, 0
    v_mov_b32 v106, 0
    v_mov_b32 v107, 0
    v_mov_b32 v108, 0
    v_mov_b32 v109, 0
    v_mov_b32 v110, 0
    v_mov_b32 v111, 0
    v_mov_b32 v112, 0
    v_mov_b32 v113, 0
    v_mov_b32 v114, 0
    v_mov_b32 v115, 0
    v_mov_b32 v116, 0
    v_mov_b32 v117, 0
    v_mov_b32 v118, 0
    v_mov_b32 v119, 0
    v_mov_b32 v120, 0
    v_mov_b32 v121, 0
    v_mov_b32 v122, 0
    v_mov_b32 v123, 0
    v_mov_b32 v124, 0
    v_mov_b32 v125, 0
    v_mov_b32 v126, 0
    v_mov_b32 v127, 0
    v_mov_b32 v209, 0xf149f2ca
    v_mov_b32 v210, 0
    s_waitcnt vmcnt(12)
    s_barrier
    s_add_u32 m0, s44, 49152
    s_add_u32 s41, s2, 1
    s_and_b32 s41, s41, 7
    s_lshl_b32 s41, s41, 14
    s_add_u32 s40, s41, s44
    buffer_load_dwordx4 v220, s[28:31], s40 offen offset:0 lds
    s_add_u32 s41, s2, 1
    s_and_b32 s41, s41, 7
    s_lshl_b32 s41, s41, 14
    s_add_u32 s40, s41, s44
    buffer_load_dwordx4 v220, s[28:31], s40 offen offset:1024 lds
    s_add_u32 s41, s2, 1
    s_and_b32 s41, s41, 7
    s_lshl_b32 s41, s41, 14
    s_add_u32 s40, s41, s44
    buffer_load_dwordx4 v220, s[28:31], s40 offen offset:2048 lds
    s_add_u32 s41, s2, 1
    s_and_b32 s41, s41, 7
    s_lshl_b32 s41, s41, 14
    s_add_u32 s40, s41, s44
    buffer_load_dwordx4 v220, s[28:31], s40 offen offset:3072 lds
    ds_read_b128 v[176:176+3], v192 offset:0
    ds_read_b128 v[180:180+3], v193 offset:0
    ds_read_b128 v[184:184+3], v194 offset:0
    ds_read_b128 v[188:188+3], v195 offset:0
    s_waitcnt lgkmcnt(3)
    v_mfma_f32_32x32x16_bf16 v[128:143], v[176:179], v[32:35], 0
    ds_read_b128 v[176:176+3], v196 offset:0
    s_waitcnt lgkmcnt(3)
    v_mfma_f32_32x32x16_bf16 v[128:143], v[180:183], v[36:39], v[128:143]
    ds_read_b128 v[180:180+3], v197 offset:0
    s_waitcnt lgkmcnt(3)
    v_mfma_f32_32x32x16_bf16 v[128:143], v[184:187], v[40:43], v[128:143]
    ds_read_b128 v[184:184+3], v198 offset:0
    s_waitcnt lgkmcnt(3)
    v_mfma_f32_32x32x16_bf16 v[128:143], v[188:191], v[44:47], v[128:143]
    ds_read_b128 v[188:188+3], v199 offset:0
    s_waitcnt lgkmcnt(3)
    v_mfma_f32_32x32x16_bf16 v[128:143], v[176:179], v[48:51], v[128:143]
    ds_read_b128 v[176:176+3], v192 offset:8192
    s_waitcnt lgkmcnt(3)
    v_mfma_f32_32x32x16_bf16 v[128:143], v[180:183], v[52:55], v[128:143]
    ds_read_b128 v[180:180+3], v193 offset:8192
    s_waitcnt lgkmcnt(3)
    v_mfma_f32_32x32x16_bf16 v[128:143], v[184:187], v[56:59], v[128:143]
    ds_read_b128 v[184:184+3], v194 offset:8192
    s_waitcnt lgkmcnt(3)
    v_mfma_f32_32x32x16_bf16 v[128:143], v[188:191], v[60:63], v[128:143]
    ds_read_b128 v[188:188+3], v195 offset:8192
    s_waitcnt lgkmcnt(3)
    v_mfma_f32_32x32x16_bf16 v[144:159], v[176:179], v[32:35], 0
    ds_read_b128 v[176:176+3], v196 offset:8192
    s_waitcnt lgkmcnt(3)
    v_mfma_f32_32x32x16_bf16 v[144:159], v[180:183], v[36:39], v[144:159]
    ds_read_b128 v[180:180+3], v197 offset:8192
    s_waitcnt lgkmcnt(3)
    v_mfma_f32_32x32x16_bf16 v[144:159], v[184:187], v[40:43], v[144:159]
    ds_read_b128 v[184:184+3], v198 offset:8192
    s_waitcnt lgkmcnt(3)
    v_mfma_f32_32x32x16_bf16 v[144:159], v[188:191], v[44:47], v[144:159]
    ds_read_b128 v[188:188+3], v199 offset:8192
    s_waitcnt lgkmcnt(3)
    v_mfma_f32_32x32x16_bf16 v[144:159], v[176:179], v[48:51], v[144:159]
    s_waitcnt lgkmcnt(2)
    v_mfma_f32_32x32x16_bf16 v[144:159], v[180:183], v[52:55], v[144:159]
    s_waitcnt lgkmcnt(1)
    v_mfma_f32_32x32x16_bf16 v[144:159], v[184:187], v[56:59], v[144:159]
    s_waitcnt lgkmcnt(0)
    v_mfma_f32_32x32x16_bf16 v[144:159], v[188:191], v[60:63], v[144:159]
    s_nop 7
    s_nop 4
    v_max3_f32 v211, v128, v129, v209
    v_max3_f32 v211, v130, v131, v211
    v_max3_f32 v211, v132, v133, v211
    v_max3_f32 v211, v134, v135, v211
    v_max3_f32 v211, v136, v137, v211
    v_max3_f32 v211, v138, v139, v211
    v_max3_f32 v211, v140, v141, v211
    v_max3_f32 v211, v142, v143, v211
    v_max3_f32 v211, v144, v145, v211
    v_max3_f32 v211, v146, v147, v211
    v_max3_f32 v211, v148, v149, v211
    v_max3_f32 v211, v150, v151, v211
    v_max3_f32 v211, v152, v153, v211
    v_max3_f32 v211, v154, v155, v211
    v_max3_f32 v211, v156, v157, v211
    v_max3_f32 v211, v158, v159, v211
    v_mov_b32 v212, v211
    s_nop 1
    v_permlane32_swap_b32 v211, v212
    s_nop 1
    v_max_f32 v211, v211, v212
    v_sub_f32 v213, v209, v211
    v_exp_f32 v213, v213
    v_mov_b32 v209, v211
    v_sub_f32 v128, v128, v211
    v_exp_f32 v128, v128
    v_sub_f32 v129, v129, v211
    v_exp_f32 v129, v129
    v_sub_f32 v130, v130, v211
    v_exp_f32 v130, v130
    v_sub_f32 v131, v131, v211
    v_exp_f32 v131, v131
    v_sub_f32 v132, v132, v211
    v_exp_f32 v132, v132
    v_sub_f32 v133, v133, v211
    v_exp_f32 v133, v133
    v_sub_f32 v134, v134, v211
    v_exp_f32 v134, v134
    v_sub_f32 v135, v135, v211
    v_exp_f32 v135, v135
    v_sub_f32 v136, v136, v211
    v_exp_f32 v136, v136
    v_sub_f32 v137, v137, v211
    v_exp_f32 v137, v137
    v_sub_f32 v138, v138, v211
    v_exp_f32 v138, v138
    v_sub_f32 v139, v139, v211
    v_exp_f32 v139, v139
    v_sub_f32 v140, v140, v211
    v_exp_f32 v140, v140
    v_sub_f32 v141, v141, v211
    v_exp_f32 v141, v141
    v_sub_f32 v142, v142, v211
    v_exp_f32 v142, v142
    v_sub_f32 v143, v143, v211
    v_exp_f32 v143, v143
    v_sub_f32 v144, v144, v211
    v_exp_f32 v144, v144
    v_sub_f32 v145, v145, v211
    v_exp_f32 v145, v145
    v_sub_f32 v146, v146, v211
    v_exp_f32 v146, v146
    v_sub_f32 v147, v147, v211
    v_exp_f32 v147, v147
    v_sub_f32 v148, v148, v211
    v_exp_f32 v148, v148
    v_sub_f32 v149, v149, v211
    v_exp_f32 v149, v149
    v_sub_f32 v150, v150, v211
    v_exp_f32 v150, v150
    v_sub_f32 v151, v151, v211
    v_exp_f32 v151, v151
    v_sub_f32 v152, v152, v211
    v_exp_f32 v152, v152
    v_sub_f32 v153, v153, v211
    v_exp_f32 v153, v153
    v_sub_f32 v154, v154, v211
    v_exp_f32 v154, v154
    v_sub_f32 v155, v155, v211
    v_exp_f32 v155, v155
    v_sub_f32 v156, v156, v211
    v_exp_f32 v156, v156
    v_sub_f32 v157, v157, v211
    v_exp_f32 v157, v157
    v_sub_f32 v158, v158, v211
    v_exp_f32 v158, v158
    v_sub_f32 v159, v159, v211
    v_exp_f32 v159, v159
    v_mul_f32 v210, v210, v213
    v_mul_f32 v64, v64, v213
    v_mul_f32 v65, v65, v213
    v_mul_f32 v66, v66, v213
    v_mul_f32 v67, v67, v213
    v_mul_f32 v68, v68, v213
    v_mul_f32 v69, v69, v213
    v_mul_f32 v70, v70, v213
    v_mul_f32 v71, v71, v213
    v_mul_f32 v72, v72, v213
    v_mul_f32 v73, v73, v213
    v_mul_f32 v74, v74, v213
    v_mul_f32 v75, v75, v213
    v_mul_f32 v76, v76, v213
    v_mul_f32 v77, v77, v213
    v_mul_f32 v78, v78, v213
    v_mul_f32 v79, v79, v213
    v_mul_f32 v80, v80, v213
    v_mul_f32 v81, v81, v213
    v_mul_f32 v82, v82, v213
    v_mul_f32 v83, v83, v213
    v_mul_f32 v84, v84, v213
    v_mul_f32 v85, v85, v213
    v_mul_f32 v86, v86, v213
    v_mul_f32 v87, v87, v213
    v_mul_f32 v88, v88, v213
    v_mul_f32 v89, v89, v213
    v_mul_f32 v90, v90, v213
    v_mul_f32 v91, v91, v213
    v_mul_f32 v92, v92, v213
    v_mul_f32 v93, v93, v213
    v_mul_f32 v94, v94, v213
    v_mul_f32 v95, v95, v213
    v_mul_f32 v96, v96, v213
    v_mul_f32 v97, v97, v213
    v_mul_f32 v98, v98, v213
    v_mul_f32 v99, v99, v213
    v_mul_f32 v100, v100, v213
    v_mul_f32 v101, v101, v213
    v_mul_f32 v102, v102, v213
    v_mul_f32 v103, v103, v213
    v_mul_f32 v104, v104, v213
    v_mul_f32 v105, v105, v213
    v_mul_f32 v106, v106, v213
    v_mul_f32 v107, v107, v213
    v_mul_f32 v108, v108, v213
    v_mul_f32 v109, v109, v213
    v_mul_f32 v110, v110, v213
    v_mul_f32 v111, v111, v213
    v_mul_f32 v112, v112, v213
    v_mul_f32 v113, v113, v213
    v_mul_f32 v114, v114, v213
    v_mul_f32 v115, v115, v213
    v_mul_f32 v116, v116, v213
    v_mul_f32 v117, v117, v213
    v_mul_f32 v118, v118, v213
    v_mul_f32 v119, v119, v213
    v_mul_f32 v120, v120, v213
    v_mul_f32 v121, v121, v213
    v_mul_f32 v122, v122, v213
    v_mul_f32 v123, v123, v213
    v_mul_f32 v124, v124, v213
    v_mul_f32 v125, v125, v213
    v_mul_f32 v126, v126, v213
    v_mul_f32 v127, v127, v213
    v_add_f32 v210, v210, v128
    v_add_f32 v210, v210, v129
    v_add_f32 v210, v210, v130
    v_add_f32 v210, v210, v131
    v_add_f32 v210, v210, v132
    v_add_f32 v210, v210, v133
    v_add_f32 v210, v210, v134
    v_add_f32 v210, v210, v135
    v_add_f32 v210, v210, v136
    v_add_f32 v210, v210, v137
    v_add_f32 v210, v210, v138
    v_add_f32 v210, v210, v139
    v_add_f32 v210, v210, v140
    v_add_f32 v210, v210, v141
    v_add_f32 v210, v210, v142
    v_add_f32 v210, v210, v143
    v_add_f32 v210, v210, v144
    v_add_f32 v210, v210, v145
    v_add_f32 v210, v210, v146
    v_add_f32 v210, v210, v147
    v_add_f32 v210, v210, v148
    v_add_f32 v210, v210, v149
    v_add_f32 v210, v210, v150
    v_add_f32 v210, v210, v151
    v_add_f32 v210, v210, v152
    v_add_f32 v210, v210, v153
    v_add_f32 v210, v210, v154
    v_add_f32 v210, v210, v155
    v_add_f32 v210, v210, v156
    v_add_f32 v210, v210, v157
    v_add_f32 v210, v210, v158
    v_add_f32 v210, v210, v159
    v_cvt_pk_bf16_f32 v160, v128, v129
    v_cvt_pk_bf16_f32 v161, v130, v131
    v_cvt_pk_bf16_f32 v162, v132, v133
    v_cvt_pk_bf16_f32 v163, v134, v135
    v_cvt_pk_bf16_f32 v164, v136, v137
    v_cvt_pk_bf16_f32 v165, v138, v139
    v_cvt_pk_bf16_f32 v166, v140, v141
    v_cvt_pk_bf16_f32 v167, v142, v143
    v_cvt_pk_bf16_f32 v168, v144, v145
    v_cvt_pk_bf16_f32 v169, v146, v147
    v_cvt_pk_bf16_f32 v170, v148, v149
    v_cvt_pk_bf16_f32 v171, v150, v151
    v_cvt_pk_bf16_f32 v172, v152, v153
    v_cvt_pk_bf16_f32 v173, v154, v155
    v_cvt_pk_bf16_f32 v174, v156, v157
    v_cvt_pk_bf16_f32 v175, v158, v159
    s_waitcnt vmcnt(8)
    s_barrier
    s_add_u32 m0, s44, 0
    s_add_u32 s41, s2, 2
    s_and_b32 s41, s41, 7
    s_lshl_b32 s41, s41, 14
    s_add_u32 s40, s41, s44
    buffer_load_dwordx4 v216, s[24:27], s40 offen offset:0 lds
    s_add_u32 s41, s2, 2
    s_and_b32 s41, s41, 7
    s_lshl_b32 s41, s41, 14
    s_add_u32 s40, s41, s44
    buffer_load_dwordx4 v217, s[24:27], s40 offen offset:1024 lds
    s_add_u32 s41, s2, 2
    s_and_b32 s41, s41, 7
    s_lshl_b32 s41, s41, 14
    s_add_u32 s40, s41, s44
    buffer_load_dwordx4 v218, s[24:27], s40 offen offset:2048 lds
    s_add_u32 s41, s2, 2
    s_and_b32 s41, s41, 7
    s_lshl_b32 s41, s41, 14
    s_add_u32 s40, s41, s44
    buffer_load_dwordx4 v219, s[24:27], s40 offen offset:3072 lds
    ds_read_b64_tr_b16 v[176:176+1], v200 offset:16384
    ds_read_b64_tr_b16 v[178:178+1], v200 offset:18432
    ds_read_b64_tr_b16 v[180:180+1], v201 offset:16384
    ds_read_b64_tr_b16 v[182:182+1], v201 offset:18432
    ds_read_b64_tr_b16 v[184:184+1], v202 offset:16384
    ds_read_b64_tr_b16 v[186:186+1], v202 offset:18432
    ds_read_b64_tr_b16 v[188:188+1], v203 offset:16384
    ds_read_b64_tr_b16 v[190:190+1], v203 offset:18432
    s_waitcnt lgkmcnt(6)
    v_mfma_f32_32x32x16_bf16 v[64:79], v[176:179], v[160:163], v[64:79]
    ds_read_b64_tr_b16 v[176:176+1], v200 offset:20480
    ds_read_b64_tr_b16 v[178:178+1], v200 offset:22528
    s_waitcnt lgkmcnt(6)
    v_mfma_f32_32x32x16_bf16 v[80:95], v[180:183], v[160:163], v[80:95]
    ds_read_b64_tr_b16 v[180:180+1], v201 offset:20480
    ds_read_b64_tr_b16 v[182:182+1], v201 offset:22528
    s_waitcnt lgkmcnt(6)
    v_mfma_f32_32x32x16_bf16 v[96:111], v[184:187], v[160:163], v[96:111]
    ds_read_b64_tr_b16 v[184:184+1], v202 offset:20480
    ds_read_b64_tr_b16 v[186:186+1], v202 offset:22528
    s_waitcnt lgkmcnt(6)
    v_mfma_f32_32x32x16_bf16 v[112:127], v[188:191], v[160:163], v[112:127]
    ds_read_b64_tr_b16 v[188:188+1], v203 offset:20480
    ds_read_b64_tr_b16 v[190:190+1], v203 offset:22528
    s_waitcnt lgkmcnt(6)
    v_mfma_f32_32x32x16_bf16 v[64:79], v[176:179], v[164:167], v[64:79]
    ds_read_b64_tr_b16 v[176:176+1], v200 offset:24576
    ds_read_b64_tr_b16 v[178:178+1], v200 offset:26624
    s_waitcnt lgkmcnt(6)
    v_mfma_f32_32x32x16_bf16 v[80:95], v[180:183], v[164:167], v[80:95]
    ds_read_b64_tr_b16 v[180:180+1], v201 offset:24576
    ds_read_b64_tr_b16 v[182:182+1], v201 offset:26624
    s_waitcnt lgkmcnt(6)
    v_mfma_f32_32x32x16_bf16 v[96:111], v[184:187], v[164:167], v[96:111]
    ds_read_b64_tr_b16 v[184:184+1], v202 offset:24576
    ds_read_b64_tr_b16 v[186:186+1], v202 offset:26624
    s_waitcnt lgkmcnt(6)
    v_mfma_f32_32x32x16_bf16 v[112:127], v[188:191], v[164:167], v[112:127]
    ds_read_b64_tr_b16 v[188:188+1], v203 offset:24576
    ds_read_b64_tr_b16 v[190:190+1], v203 offset:26624
    s_waitcnt lgkmcnt(6)
    v_mfma_f32_32x32x16_bf16 v[64:79], v[176:179], v[168:171], v[64:79]
    ds_read_b64_tr_b16 v[176:176+1], v200 offset:28672
    ds_read_b64_tr_b16 v[178:178+1], v200 offset:30720
    s_waitcnt lgkmcnt(6)
    v_mfma_f32_32x32x16_bf16 v[80:95], v[180:183], v[168:171], v[80:95]
    ds_read_b64_tr_b16 v[180:180+1], v201 offset:28672
    ds_read_b64_tr_b16 v[182:182+1], v201 offset:30720
    s_waitcnt lgkmcnt(6)
    v_mfma_f32_32x32x16_bf16 v[96:111], v[184:187], v[168:171], v[96:111]
    ds_read_b64_tr_b16 v[184:184+1], v202 offset:28672
    ds_read_b64_tr_b16 v[186:186+1], v202 offset:30720
    s_waitcnt lgkmcnt(6)
    v_mfma_f32_32x32x16_bf16 v[112:127], v[188:191], v[168:171], v[112:127]
    ds_read_b64_tr_b16 v[188:188+1], v203 offset:28672
    ds_read_b64_tr_b16 v[190:190+1], v203 offset:30720
    s_waitcnt lgkmcnt(6)
    v_mfma_f32_32x32x16_bf16 v[64:79], v[176:179], v[172:175], v[64:79]
    s_waitcnt lgkmcnt(4)
    v_mfma_f32_32x32x16_bf16 v[80:95], v[180:183], v[172:175], v[80:95]
    s_waitcnt lgkmcnt(2)
    v_mfma_f32_32x32x16_bf16 v[96:111], v[184:187], v[172:175], v[96:111]
    s_waitcnt lgkmcnt(0)
    v_mfma_f32_32x32x16_bf16 v[112:127], v[188:191], v[172:175], v[112:127]
    s_waitcnt vmcnt(8)
    s_barrier
    s_add_u32 m0, s44, 16384
    s_add_u32 s41, s2, 2
    s_and_b32 s41, s41, 7
    s_lshl_b32 s41, s41, 14
    s_add_u32 s40, s41, s44
    buffer_load_dwordx4 v220, s[28:31], s40 offen offset:0 lds
    s_add_u32 s41, s2, 2
    s_and_b32 s41, s41, 7
    s_lshl_b32 s41, s41, 14
    s_add_u32 s40, s41, s44
    buffer_load_dwordx4 v220, s[28:31], s40 offen offset:1024 lds
    s_add_u32 s41, s2, 2
    s_and_b32 s41, s41, 7
    s_lshl_b32 s41, s41, 14
    s_add_u32 s40, s41, s44
    buffer_load_dwordx4 v220, s[28:31], s40 offen offset:2048 lds
    s_add_u32 s41, s2, 2
    s_and_b32 s41, s41, 7
    s_lshl_b32 s41, s41, 14
    s_add_u32 s40, s41, s44
    buffer_load_dwordx4 v220, s[28:31], s40 offen offset:3072 lds
    ds_read_b128 v[176:176+3], v192 offset:32768
    ds_read_b128 v[180:180+3], v193 offset:32768
    ds_read_b128 v[184:184+3], v194 offset:32768
    ds_read_b128 v[188:188+3], v195 offset:32768
    s_waitcnt lgkmcnt(3)
    v_mfma_f32_32x32x16_bf16 v[128:143], v[176:179], v[32:35], 0
    ds_read_b128 v[176:176+3], v196 offset:32768
    s_waitcnt lgkmcnt(3)
    v_mfma_f32_32x32x16_bf16 v[128:143], v[180:183], v[36:39], v[128:143]
    ds_read_b128 v[180:180+3], v197 offset:32768
    s_waitcnt lgkmcnt(3)
    v_mfma_f32_32x32x16_bf16 v[128:143], v[184:187], v[40:43], v[128:143]
    ds_read_b128 v[184:184+3], v198 offset:32768
    s_waitcnt lgkmcnt(3)
    v_mfma_f32_32x32x16_bf16 v[128:143], v[188:191], v[44:47], v[128:143]
    ds_read_b128 v[188:188+3], v199 offset:32768
    s_waitcnt lgkmcnt(3)
    v_mfma_f32_32x32x16_bf16 v[128:143], v[176:179], v[48:51], v[128:143]
    ds_read_b128 v[176:176+3], v192 offset:40960
    s_waitcnt lgkmcnt(3)
    v_mfma_f32_32x32x16_bf16 v[128:143], v[180:183], v[52:55], v[128:143]
    ds_read_b128 v[180:180+3], v193 offset:40960
    s_waitcnt lgkmcnt(3)
    v_mfma_f32_32x32x16_bf16 v[128:143], v[184:187], v[56:59], v[128:143]
    ds_read_b128 v[184:184+3], v194 offset:40960
    s_waitcnt lgkmcnt(3)
    v_mfma_f32_32x32x16_bf16 v[128:143], v[188:191], v[60:63], v[128:143]
    ds_read_b128 v[188:188+3], v195 offset:40960
    s_waitcnt lgkmcnt(3)
    v_mfma_f32_32x32x16_bf16 v[144:159], v[176:179], v[32:35], 0
    ds_read_b128 v[176:176+3], v196 offset:40960
    s_waitcnt lgkmcnt(3)
    v_mfma_f32_32x32x16_bf16 v[144:159], v[180:183], v[36:39], v[144:159]
    ds_read_b128 v[180:180+3], v197 offset:40960
    s_waitcnt lgkmcnt(3)
    v_mfma_f32_32x32x16_bf16 v[144:159], v[184:187], v[40:43], v[144:159]
    ds_read_b128 v[184:184+3], v198 offset:40960
    s_waitcnt lgkmcnt(3)
    v_mfma_f32_32x32x16_bf16 v[144:159], v[188:191], v[44:47], v[144:159]
    ds_read_b128 v[188:188+3], v199 offset:40960
    s_waitcnt lgkmcnt(3)
    v_mfma_f32_32x32x16_bf16 v[144:159], v[176:179], v[48:51], v[144:159]
    s_waitcnt lgkmcnt(2)
    v_mfma_f32_32x32x16_bf16 v[144:159], v[180:183], v[52:55], v[144:159]
    s_waitcnt lgkmcnt(1)
    v_mfma_f32_32x32x16_bf16 v[144:159], v[184:187], v[56:59], v[144:159]
    s_waitcnt lgkmcnt(0)
    v_mfma_f32_32x32x16_bf16 v[144:159], v[188:191], v[60:63], v[144:159]
    s_nop 7
    s_nop 4
    v_max3_f32 v211, v128, v129, v209
    v_max3_f32 v211, v130, v131, v211
    v_max3_f32 v211, v132, v133, v211
    v_max3_f32 v211, v134, v135, v211
    v_max3_f32 v211, v136, v137, v211
    v_max3_f32 v211, v138, v139, v211
    v_max3_f32 v211, v140, v141, v211
    v_max3_f32 v211, v142, v143, v211
    v_max3_f32 v211, v144, v145, v211
    v_max3_f32 v211, v146, v147, v211
    v_max3_f32 v211, v148, v149, v211
    v_max3_f32 v211, v150, v151, v211
    v_max3_f32 v211, v152, v153, v211
    v_max3_f32 v211, v154, v155, v211
    v_max3_f32 v211, v156, v157, v211
    v_max3_f32 v211, v158, v159, v211
    v_mov_b32 v212, v211
    s_nop 1
    v_permlane32_swap_b32 v211, v212
    s_nop 1
    v_max_f32 v211, v211, v212
    v_sub_f32 v213, v209, v211
    v_exp_f32 v213, v213
    v_mov_b32 v209, v211
    v_sub_f32 v128, v128, v211
    v_exp_f32 v128, v128
    v_sub_f32 v129, v129, v211
    v_exp_f32 v129, v129
    v_sub_f32 v130, v130, v211
    v_exp_f32 v130, v130
    v_sub_f32 v131, v131, v211
    v_exp_f32 v131, v131
    v_sub_f32 v132, v132, v211
    v_exp_f32 v132, v132
    v_sub_f32 v133, v133, v211
    v_exp_f32 v133, v133
    v_sub_f32 v134, v134, v211
    v_exp_f32 v134, v134
    v_sub_f32 v135, v135, v211
    v_exp_f32 v135, v135
    v_sub_f32 v136, v136, v211
    v_exp_f32 v136, v136
    v_sub_f32 v137, v137, v211
    v_exp_f32 v137, v137
    v_sub_f32 v138, v138, v211
    v_exp_f32 v138, v138
    v_sub_f32 v139, v139, v211
    v_exp_f32 v139, v139
    v_sub_f32 v140, v140, v211
    v_exp_f32 v140, v140
    v_sub_f32 v141, v141, v211
    v_exp_f32 v141, v141
    v_sub_f32 v142, v142, v211
    v_exp_f32 v142, v142
    v_sub_f32 v143, v143, v211
    v_exp_f32 v143, v143
    v_sub_f32 v144, v144, v211
    v_exp_f32 v144, v144
    v_sub_f32 v145, v145, v211
    v_exp_f32 v145, v145
    v_sub_f32 v146, v146, v211
    v_exp_f32 v146, v146
    v_sub_f32 v147, v147, v211
    v_exp_f32 v147, v147
    v_sub_f32 v148, v148, v211
    v_exp_f32 v148, v148
    v_sub_f32 v149, v149, v211
    v_exp_f32 v149, v149
    v_sub_f32 v150, v150, v211
    v_exp_f32 v150, v150
    v_sub_f32 v151, v151, v211
    v_exp_f32 v151, v151
    v_sub_f32 v152, v152, v211
    v_exp_f32 v152, v152
    v_sub_f32 v153, v153, v211
    v_exp_f32 v153, v153
    v_sub_f32 v154, v154, v211
    v_exp_f32 v154, v154
    v_sub_f32 v155, v155, v211
    v_exp_f32 v155, v155
    v_sub_f32 v156, v156, v211
    v_exp_f32 v156, v156
    v_sub_f32 v157, v157, v211
    v_exp_f32 v157, v157
    v_sub_f32 v158, v158, v211
    v_exp_f32 v158, v158
    v_sub_f32 v159, v159, v211
    v_exp_f32 v159, v159
    v_mul_f32 v210, v210, v213
    v_mul_f32 v64, v64, v213
    v_mul_f32 v65, v65, v213
    v_mul_f32 v66, v66, v213
    v_mul_f32 v67, v67, v213
    v_mul_f32 v68, v68, v213
    v_mul_f32 v69, v69, v213
    v_mul_f32 v70, v70, v213
    v_mul_f32 v71, v71, v213
    v_mul_f32 v72, v72, v213
    v_mul_f32 v73, v73, v213
    v_mul_f32 v74, v74, v213
    v_mul_f32 v75, v75, v213
    v_mul_f32 v76, v76, v213
    v_mul_f32 v77, v77, v213
    v_mul_f32 v78, v78, v213
    v_mul_f32 v79, v79, v213
    v_mul_f32 v80, v80, v213
    v_mul_f32 v81, v81, v213
    v_mul_f32 v82, v82, v213
    v_mul_f32 v83, v83, v213
    v_mul_f32 v84, v84, v213
    v_mul_f32 v85, v85, v213
    v_mul_f32 v86, v86, v213
    v_mul_f32 v87, v87, v213
    v_mul_f32 v88, v88, v213
    v_mul_f32 v89, v89, v213
    v_mul_f32 v90, v90, v213
    v_mul_f32 v91, v91, v213
    v_mul_f32 v92, v92, v213
    v_mul_f32 v93, v93, v213
    v_mul_f32 v94, v94, v213
    v_mul_f32 v95, v95, v213
    v_mul_f32 v96, v96, v213
    v_mul_f32 v97, v97, v213
    v_mul_f32 v98, v98, v213
    v_mul_f32 v99, v99, v213
    v_mul_f32 v100, v100, v213
    v_mul_f32 v101, v101, v213
    v_mul_f32 v102, v102, v213
    v_mul_f32 v103, v103, v213
    v_mul_f32 v104, v104, v213
    v_mul_f32 v105, v105, v213
    v_mul_f32 v106, v106, v213
    v_mul_f32 v107, v107, v213
    v_mul_f32 v108, v108, v213
    v_mul_f32 v109, v109, v213
    v_mul_f32 v110, v110, v213
    v_mul_f32 v111, v111, v213
    v_mul_f32 v112, v112, v213
    v_mul_f32 v113, v113, v213
    v_mul_f32 v114, v114, v213
    v_mul_f32 v115, v115, v213
    v_mul_f32 v116, v116, v213
    v_mul_f32 v117, v117, v213
    v_mul_f32 v118, v118, v213
    v_mul_f32 v119, v119, v213
    v_mul_f32 v120, v120, v213
    v_mul_f32 v121, v121, v213
    v_mul_f32 v122, v122, v213
    v_mul_f32 v123, v123, v213
    v_mul_f32 v124, v124, v213
    v_mul_f32 v125, v125, v213
    v_mul_f32 v126, v126, v213
    v_mul_f32 v127, v127, v213
    v_add_f32 v210, v210, v128
    v_add_f32 v210, v210, v129
    v_add_f32 v210, v210, v130
    v_add_f32 v210, v210, v131
    v_add_f32 v210, v210, v132
    v_add_f32 v210, v210, v133
    v_add_f32 v210, v210, v134
    v_add_f32 v210, v210, v135
    v_add_f32 v210, v210, v136
    v_add_f32 v210, v210, v137
    v_add_f32 v210, v210, v138
    v_add_f32 v210, v210, v139
    v_add_f32 v210, v210, v140
    v_add_f32 v210, v210, v141
    v_add_f32 v210, v210, v142
    v_add_f32 v210, v210, v143
    v_add_f32 v210, v210, v144
    v_add_f32 v210, v210, v145
    v_add_f32 v210, v210, v146
    v_add_f32 v210, v210, v147
    v_add_f32 v210, v210, v148
    v_add_f32 v210, v210, v149
    v_add_f32 v210, v210, v150
    v_add_f32 v210, v210, v151
    v_add_f32 v210, v210, v152
    v_add_f32 v210, v210, v153
    v_add_f32 v210, v210, v154
    v_add_f32 v210, v210, v155
    v_add_f32 v210, v210, v156
    v_add_f32 v210, v210, v157
    v_add_f32 v210, v210, v158
    v_add_f32 v210, v210, v159
    v_cvt_pk_bf16_f32 v160, v128, v129
    v_cvt_pk_bf16_f32 v161, v130, v131
    v_cvt_pk_bf16_f32 v162, v132, v133
    v_cvt_pk_bf16_f32 v163, v134, v135
    v_cvt_pk_bf16_f32 v164, v136, v137
    v_cvt_pk_bf16_f32 v165, v138, v139
    v_cvt_pk_bf16_f32 v166, v140, v141
    v_cvt_pk_bf16_f32 v167, v142, v143
    v_cvt_pk_bf16_f32 v168, v144, v145
    v_cvt_pk_bf16_f32 v169, v146, v147
    v_cvt_pk_bf16_f32 v170, v148, v149
    v_cvt_pk_bf16_f32 v171, v150, v151
    v_cvt_pk_bf16_f32 v172, v152, v153
    v_cvt_pk_bf16_f32 v173, v154, v155
    v_cvt_pk_bf16_f32 v174, v156, v157
    v_cvt_pk_bf16_f32 v175, v158, v159
    s_waitcnt vmcnt(8)
    s_barrier
    s_add_u32 m0, s44, 32768
    s_add_u32 s41, s2, 3
    s_and_b32 s41, s41, 7
    s_lshl_b32 s41, s41, 14
    s_add_u32 s40, s41, s44
    buffer_load_dwordx4 v216, s[24:27], s40 offen offset:0 lds
    s_add_u32 s41, s2, 3
    s_and_b32 s41, s41, 7
    s_lshl_b32 s41, s41, 14
    s_add_u32 s40, s41, s44
    buffer_load_dwordx4 v217, s[24:27], s40 offen offset:1024 lds
    s_add_u32 s41, s2, 3
    s_and_b32 s41, s41, 7
    s_lshl_b32 s41, s41, 14
    s_add_u32 s40, s41, s44
    buffer_load_dwordx4 v218, s[24:27], s40 offen offset:2048 lds
    s_add_u32 s41, s2, 3
    s_and_b32 s41, s41, 7
    s_lshl_b32 s41, s41, 14
    s_add_u32 s40, s41, s44
    buffer_load_dwordx4 v219, s[24:27], s40 offen offset:3072 lds
    ds_read_b64_tr_b16 v[176:176+1], v200 offset:49152
    ds_read_b64_tr_b16 v[178:178+1], v200 offset:51200
    ds_read_b64_tr_b16 v[180:180+1], v201 offset:49152
    ds_read_b64_tr_b16 v[182:182+1], v201 offset:51200
    ds_read_b64_tr_b16 v[184:184+1], v202 offset:49152
    ds_read_b64_tr_b16 v[186:186+1], v202 offset:51200
    ds_read_b64_tr_b16 v[188:188+1], v203 offset:49152
    ds_read_b64_tr_b16 v[190:190+1], v203 offset:51200
    s_waitcnt lgkmcnt(6)
    v_mfma_f32_32x32x16_bf16 v[64:79], v[176:179], v[160:163], v[64:79]
    ds_read_b64_tr_b16 v[176:176+1], v200 offset:53248
    ds_read_b64_tr_b16 v[178:178+1], v200 offset:55296
    s_waitcnt lgkmcnt(6)
    v_mfma_f32_32x32x16_bf16 v[80:95], v[180:183], v[160:163], v[80:95]
    ds_read_b64_tr_b16 v[180:180+1], v201 offset:53248
    ds_read_b64_tr_b16 v[182:182+1], v201 offset:55296
    s_waitcnt lgkmcnt(6)
    v_mfma_f32_32x32x16_bf16 v[96:111], v[184:187], v[160:163], v[96:111]
    ds_read_b64_tr_b16 v[184:184+1], v202 offset:53248
    ds_read_b64_tr_b16 v[186:186+1], v202 offset:55296
    s_waitcnt lgkmcnt(6)
    v_mfma_f32_32x32x16_bf16 v[112:127], v[188:191], v[160:163], v[112:127]
    ds_read_b64_tr_b16 v[188:188+1], v203 offset:53248
    ds_read_b64_tr_b16 v[190:190+1], v203 offset:55296
    s_waitcnt lgkmcnt(6)
    v_mfma_f32_32x32x16_bf16 v[64:79], v[176:179], v[164:167], v[64:79]
    ds_read_b64_tr_b16 v[176:176+1], v200 offset:57344
    ds_read_b64_tr_b16 v[178:178+1], v200 offset:59392
    s_waitcnt lgkmcnt(6)
    v_mfma_f32_32x32x16_bf16 v[80:95], v[180:183], v[164:167], v[80:95]
    ds_read_b64_tr_b16 v[180:180+1], v201 offset:57344
    ds_read_b64_tr_b16 v[182:182+1], v201 offset:59392
    s_waitcnt lgkmcnt(6)
    v_mfma_f32_32x32x16_bf16 v[96:111], v[184:187], v[164:167], v[96:111]
    ds_read_b64_tr_b16 v[184:184+1], v202 offset:57344
    ds_read_b64_tr_b16 v[186:186+1], v202 offset:59392
    s_waitcnt lgkmcnt(6)
    v_mfma_f32_32x32x16_bf16 v[112:127], v[188:191], v[164:167], v[112:127]
    ds_read_b64_tr_b16 v[188:188+1], v203 offset:57344
    ds_read_b64_tr_b16 v[190:190+1], v203 offset:59392
    s_waitcnt lgkmcnt(6)
    v_mfma_f32_32x32x16_bf16 v[64:79], v[176:179], v[168:171], v[64:79]
    ds_read_b64_tr_b16 v[176:176+1], v200 offset:61440
    ds_read_b64_tr_b16 v[178:178+1], v200 offset:63488
    s_waitcnt lgkmcnt(6)
    v_mfma_f32_32x32x16_bf16 v[80:95], v[180:183], v[168:171], v[80:95]
    ds_read_b64_tr_b16 v[180:180+1], v201 offset:61440
    ds_read_b64_tr_b16 v[182:182+1], v201 offset:63488
    s_waitcnt lgkmcnt(6)
    v_mfma_f32_32x32x16_bf16 v[96:111], v[184:187], v[168:171], v[96:111]
    ds_read_b64_tr_b16 v[184:184+1], v202 offset:61440
    ds_read_b64_tr_b16 v[186:186+1], v202 offset:63488
    s_waitcnt lgkmcnt(6)
    v_mfma_f32_32x32x16_bf16 v[112:127], v[188:191], v[168:171], v[112:127]
    ds_read_b64_tr_b16 v[188:188+1], v203 offset:61440
    ds_read_b64_tr_b16 v[190:190+1], v203 offset:63488
    s_waitcnt lgkmcnt(6)
    v_mfma_f32_32x32x16_bf16 v[64:79], v[176:179], v[172:175], v[64:79]
    s_waitcnt lgkmcnt(4)
    v_mfma_f32_32x32x16_bf16 v[80:95], v[180:183], v[172:175], v[80:95]
    s_waitcnt lgkmcnt(2)
    v_mfma_f32_32x32x16_bf16 v[96:111], v[184:187], v[172:175], v[96:111]
    s_waitcnt lgkmcnt(0)
    v_mfma_f32_32x32x16_bf16 v[112:127], v[188:191], v[172:175], v[112:127]
    s_waitcnt vmcnt(8)
    s_barrier
    s_add_u32 m0, s44, 49152
    s_add_u32 s41, s2, 3
    s_and_b32 s41, s41, 7
    s_lshl_b32 s41, s41, 14
    s_add_u32 s40, s41, s44
    buffer_load_dwordx4 v220, s[28:31], s40 offen offset:0 lds
    s_add_u32 s41, s2, 3
    s_and_b32 s41, s41, 7
    s_lshl_b32 s41, s41, 14
    s_add_u32 s40, s41, s44
    buffer_load_dwordx4 v220, s[28:31], s40 offen offset:1024 lds
    s_add_u32 s41, s2, 3
    s_and_b32 s41, s41, 7
    s_lshl_b32 s41, s41, 14
    s_add_u32 s40, s41, s44
    buffer_load_dwordx4 v220, s[28:31], s40 offen offset:2048 lds
    s_add_u32 s41, s2, 3
    s_and_b32 s41, s41, 7
    s_lshl_b32 s41, s41, 14
    s_add_u32 s40, s41, s44
    buffer_load_dwordx4 v220, s[28:31], s40 offen offset:3072 lds
    ds_read_b128 v[176:176+3], v192 offset:0
    ds_read_b128 v[180:180+3], v193 offset:0
    ds_read_b128 v[184:184+3], v194 offset:0
    ds_read_b128 v[188:188+3], v195 offset:0
    s_waitcnt lgkmcnt(3)
    v_mfma_f32_32x32x16_bf16 v[128:143], v[176:179], v[32:35], 0
    ds_read_b128 v[176:176+3], v196 offset:0
    s_waitcnt lgkmcnt(3)
    v_mfma_f32_32x32x16_bf16 v[128:143], v[180:183], v[36:39], v[128:143]
    ds_read_b128 v[180:180+3], v197 offset:0
    s_waitcnt lgkmcnt(3)
    v_mfma_f32_32x32x16_bf16 v[128:143], v[184:187], v[40:43], v[128:143]
    ds_read_b128 v[184:184+3], v198 offset:0
    s_waitcnt lgkmcnt(3)
    v_mfma_f32_32x32x16_bf16 v[128:143], v[188:191], v[44:47], v[128:143]
    ds_read_b128 v[188:188+3], v199 offset:0
    s_waitcnt lgkmcnt(3)
    v_mfma_f32_32x32x16_bf16 v[128:143], v[176:179], v[48:51], v[128:143]
    ds_read_b128 v[176:176+3], v192 offset:8192
    s_waitcnt lgkmcnt(3)
    v_mfma_f32_32x32x16_bf16 v[128:143], v[180:183], v[52:55], v[128:143]
    ds_read_b128 v[180:180+3], v193 offset:8192
    s_waitcnt lgkmcnt(3)
    v_mfma_f32_32x32x16_bf16 v[128:143], v[184:187], v[56:59], v[128:143]
    ds_read_b128 v[184:184+3], v194 offset:8192
    s_waitcnt lgkmcnt(3)
    v_mfma_f32_32x32x16_bf16 v[128:143], v[188:191], v[60:63], v[128:143]
    ds_read_b128 v[188:188+3], v195 offset:8192
    s_waitcnt lgkmcnt(3)
    v_mfma_f32_32x32x16_bf16 v[144:159], v[176:179], v[32:35], 0
    ds_read_b128 v[176:176+3], v196 offset:8192
    s_waitcnt lgkmcnt(3)
    v_mfma_f32_32x32x16_bf16 v[144:159], v[180:183], v[36:39], v[144:159]
    ds_read_b128 v[180:180+3], v197 offset:8192
    s_waitcnt lgkmcnt(3)
    v_mfma_f32_32x32x16_bf16 v[144:159], v[184:187], v[40:43], v[144:159]
    ds_read_b128 v[184:184+3], v198 offset:8192
    s_waitcnt lgkmcnt(3)
    v_mfma_f32_32x32x16_bf16 v[144:159], v[188:191], v[44:47], v[144:159]
    ds_read_b128 v[188:188+3], v199 offset:8192
    s_waitcnt lgkmcnt(3)
    v_mfma_f32_32x32x16_bf16 v[144:159], v[176:179], v[48:51], v[144:159]
    s_waitcnt lgkmcnt(2)
    v_mfma_f32_32x32x16_bf16 v[144:159], v[180:183], v[52:55], v[144:159]
    s_waitcnt lgkmcnt(1)
    v_mfma_f32_32x32x16_bf16 v[144:159], v[184:187], v[56:59], v[144:159]
    s_waitcnt lgkmcnt(0)
    v_mfma_f32_32x32x16_bf16 v[144:159], v[188:191], v[60:63], v[144:159]
    s_nop 7
    s_nop 4
    v_max3_f32 v211, v128, v129, v209
    v_max3_f32 v211, v130, v131, v211
    v_max3_f32 v211, v132, v133, v211
    v_max3_f32 v211, v134, v135, v211
    v_max3_f32 v211, v136, v137, v211
    v_max3_f32 v211, v138, v139, v211
    v_max3_f32 v211, v140, v141, v211
    v_max3_f32 v211, v142, v143, v211
    v_max3_f32 v211, v144, v145, v211
    v_max3_f32 v211, v146, v147, v211
    v_max3_f32 v211, v148, v149, v211
    v_max3_f32 v211, v150, v151, v211
    v_max3_f32 v211, v152, v153, v211
    v_max3_f32 v211, v154, v155, v211
    v_max3_f32 v211, v156, v157, v211
    v_max3_f32 v211, v158, v159, v211
    v_mov_b32 v212, v211
    s_nop 1
    v_permlane32_swap_b32 v211, v212
    s_nop 1
    v_max_f32 v211, v211, v212
    v_sub_f32 v213, v209, v211
    v_exp_f32 v213, v213
    v_mov_b32 v209, v211
    v_sub_f32 v128, v128, v211
    v_exp_f32 v128, v128
    v_sub_f32 v129, v129, v211
    v_exp_f32 v129, v129
    v_sub_f32 v130, v130, v211
    v_exp_f32 v130, v130
    v_sub_f32 v131, v131, v211
    v_exp_f32 v131, v131
    v_sub_f32 v132, v132, v211
    v_exp_f32 v132, v132
    v_sub_f32 v133, v133, v211
    v_exp_f32 v133, v133
    v_sub_f32 v134, v134, v211
    v_exp_f32 v134, v134
    v_sub_f32 v135, v135, v211
    v_exp_f32 v135, v135
    v_sub_f32 v136, v136, v211
    v_exp_f32 v136, v136
    v_sub_f32 v137, v137, v211
    v_exp_f32 v137, v137
    v_sub_f32 v138, v138, v211
    v_exp_f32 v138, v138
    v_sub_f32 v139, v139, v211
    v_exp_f32 v139, v139
    v_sub_f32 v140, v140, v211
    v_exp_f32 v140, v140
    v_sub_f32 v141, v141, v211
    v_exp_f32 v141, v141
    v_sub_f32 v142, v142, v211
    v_exp_f32 v142, v142
    v_sub_f32 v143, v143, v211
    v_exp_f32 v143, v143
    v_sub_f32 v144, v144, v211
    v_exp_f32 v144, v144
    v_sub_f32 v145, v145, v211
    v_exp_f32 v145, v145
    v_sub_f32 v146, v146, v211
    v_exp_f32 v146, v146
    v_sub_f32 v147, v147, v211
    v_exp_f32 v147, v147
    v_sub_f32 v148, v148, v211
    v_exp_f32 v148, v148
    v_sub_f32 v149, v149, v211
    v_exp_f32 v149, v149
    v_sub_f32 v150, v150, v211
    v_exp_f32 v150, v150
    v_sub_f32 v151, v151, v211
    v_exp_f32 v151, v151
    v_sub_f32 v152, v152, v211
    v_exp_f32 v152, v152
    v_sub_f32 v153, v153, v211
    v_exp_f32 v153, v153
    v_sub_f32 v154, v154, v211
    v_exp_f32 v154, v154
    v_sub_f32 v155, v155, v211
    v_exp_f32 v155, v155
    v_sub_f32 v156, v156, v211
    v_exp_f32 v156, v156
    v_sub_f32 v157, v157, v211
    v_exp_f32 v157, v157
    v_sub_f32 v158, v158, v211
    v_exp_f32 v158, v158
    v_sub_f32 v159, v159, v211
    v_exp_f32 v159, v159
    v_mul_f32 v210, v210, v213
    v_mul_f32 v64, v64, v213
    v_mul_f32 v65, v65, v213
    v_mul_f32 v66, v66, v213
    v_mul_f32 v67, v67, v213
    v_mul_f32 v68, v68, v213
    v_mul_f32 v69, v69, v213
    v_mul_f32 v70, v70, v213
    v_mul_f32 v71, v71, v213
    v_mul_f32 v72, v72, v213
    v_mul_f32 v73, v73, v213
    v_mul_f32 v74, v74, v213
    v_mul_f32 v75, v75, v213
    v_mul_f32 v76, v76, v213
    v_mul_f32 v77, v77, v213
    v_mul_f32 v78, v78, v213
    v_mul_f32 v79, v79, v213
    v_mul_f32 v80, v80, v213
    v_mul_f32 v81, v81, v213
    v_mul_f32 v82, v82, v213
    v_mul_f32 v83, v83, v213
    v_mul_f32 v84, v84, v213
    v_mul_f32 v85, v85, v213
    v_mul_f32 v86, v86, v213
    v_mul_f32 v87, v87, v213
    v_mul_f32 v88, v88, v213
    v_mul_f32 v89, v89, v213
    v_mul_f32 v90, v90, v213
    v_mul_f32 v91, v91, v213
    v_mul_f32 v92, v92, v213
    v_mul_f32 v93, v93, v213
    v_mul_f32 v94, v94, v213
    v_mul_f32 v95, v95, v213
    v_mul_f32 v96, v96, v213
    v_mul_f32 v97, v97, v213
    v_mul_f32 v98, v98, v213
    v_mul_f32 v99, v99, v213
    v_mul_f32 v100, v100, v213
    v_mul_f32 v101, v101, v213
    v_mul_f32 v102, v102, v213
    v_mul_f32 v103, v103, v213
    v_mul_f32 v104, v104, v213
    v_mul_f32 v105, v105, v213
    v_mul_f32 v106, v106, v213
    v_mul_f32 v107, v107, v213
    v_mul_f32 v108, v108, v213
    v_mul_f32 v109, v109, v213
    v_mul_f32 v110, v110, v213
    v_mul_f32 v111, v111, v213
    v_mul_f32 v112, v112, v213
    v_mul_f32 v113, v113, v213
    v_mul_f32 v114, v114, v213
    v_mul_f32 v115, v115, v213
    v_mul_f32 v116, v116, v213
    v_mul_f32 v117, v117, v213
    v_mul_f32 v118, v118, v213
    v_mul_f32 v119, v119, v213
    v_mul_f32 v120, v120, v213
    v_mul_f32 v121, v121, v213
    v_mul_f32 v122, v122, v213
    v_mul_f32 v123, v123, v213
    v_mul_f32 v124, v124, v213
    v_mul_f32 v125, v125, v213
    v_mul_f32 v126, v126, v213
    v_mul_f32 v127, v127, v213
    v_add_f32 v210, v210, v128
    v_add_f32 v210, v210, v129
    v_add_f32 v210, v210, v130
    v_add_f32 v210, v210, v131
    v_add_f32 v210, v210, v132
    v_add_f32 v210, v210, v133
    v_add_f32 v210, v210, v134
    v_add_f32 v210, v210, v135
    v_add_f32 v210, v210, v136
    v_add_f32 v210, v210, v137
    v_add_f32 v210, v210, v138
    v_add_f32 v210, v210, v139
    v_add_f32 v210, v210, v140
    v_add_f32 v210, v210, v141
    v_add_f32 v210, v210, v142
    v_add_f32 v210, v210, v143
    v_add_f32 v210, v210, v144
    v_add_f32 v210, v210, v145
    v_add_f32 v210, v210, v146
    v_add_f32 v210, v210, v147
    v_add_f32 v210, v210, v148
    v_add_f32 v210, v210, v149
    v_add_f32 v210, v210, v150
    v_add_f32 v210, v210, v151
    v_add_f32 v210, v210, v152
    v_add_f32 v210, v210, v153
    v_add_f32 v210, v210, v154
    v_add_f32 v210, v210, v155
    v_add_f32 v210, v210, v156
    v_add_f32 v210, v210, v157
    v_add_f32 v210, v210, v158
    v_add_f32 v210, v210, v159
    v_cvt_pk_bf16_f32 v160, v128, v129
    v_cvt_pk_bf16_f32 v161, v130, v131
    v_cvt_pk_bf16_f32 v162, v132, v133
    v_cvt_pk_bf16_f32 v163, v134, v135
    v_cvt_pk_bf16_f32 v164, v136, v137
    v_cvt_pk_bf16_f32 v165, v138, v139
    v_cvt_pk_bf16_f32 v166, v140, v141
    v_cvt_pk_bf16_f32 v167, v142, v143
    v_cvt_pk_bf16_f32 v168, v144, v145
    v_cvt_pk_bf16_f32 v169, v146, v147
    v_cvt_pk_bf16_f32 v170, v148, v149
    v_cvt_pk_bf16_f32 v171, v150, v151
    v_cvt_pk_bf16_f32 v172, v152, v153
    v_cvt_pk_bf16_f32 v173, v154, v155
    v_cvt_pk_bf16_f32 v174, v156, v157
    v_cvt_pk_bf16_f32 v175, v158, v159
    s_waitcnt vmcnt(8)
    s_barrier
    s_add_u32 m0, s44, 0
    s_add_u32 s41, s2, 4
    s_and_b32 s41, s41, 7
    s_lshl_b32 s41, s41, 14
    s_add_u32 s40, s41, s44
    buffer_load_dwordx4 v216, s[24:27], s40 offen offset:0 lds
    s_add_u32 s41, s2, 4
    s_and_b32 s41, s41, 7
    s_lshl_b32 s41, s41, 14
    s_add_u32 s40, s41, s44
    buffer_load_dwordx4 v217, s[24:27], s40 offen offset:1024 lds
    s_add_u32 s41, s2, 4
    s_and_b32 s41, s41, 7
    s_lshl_b32 s41, s41, 14
    s_add_u32 s40, s41, s44
    buffer_load_dwordx4 v218, s[24:27], s40 offen offset:2048 lds
    s_add_u32 s41, s2, 4
    s_and_b32 s41, s41, 7
    s_lshl_b32 s41, s41, 14
    s_add_u32 s40, s41, s44
    buffer_load_dwordx4 v219, s[24:27], s40 offen offset:3072 lds
    ds_read_b64_tr_b16 v[176:176+1], v200 offset:16384
    ds_read_b64_tr_b16 v[178:178+1], v200 offset:18432
    ds_read_b64_tr_b16 v[180:180+1], v201 offset:16384
    ds_read_b64_tr_b16 v[182:182+1], v201 offset:18432
    ds_read_b64_tr_b16 v[184:184+1], v202 offset:16384
    ds_read_b64_tr_b16 v[186:186+1], v202 offset:18432
    ds_read_b64_tr_b16 v[188:188+1], v203 offset:16384
    ds_read_b64_tr_b16 v[190:190+1], v203 offset:18432
    s_waitcnt lgkmcnt(6)
    v_mfma_f32_32x32x16_bf16 v[64:79], v[176:179], v[160:163], v[64:79]
    ds_read_b64_tr_b16 v[176:176+1], v200 offset:20480
    ds_read_b64_tr_b16 v[178:178+1], v200 offset:22528
    s_waitcnt lgkmcnt(6)
    v_mfma_f32_32x32x16_bf16 v[80:95], v[180:183], v[160:163], v[80:95]
    ds_read_b64_tr_b16 v[180:180+1], v201 offset:20480
    ds_read_b64_tr_b16 v[182:182+1], v201 offset:22528
    s_waitcnt lgkmcnt(6)
    v_mfma_f32_32x32x16_bf16 v[96:111], v[184:187], v[160:163], v[96:111]
    ds_read_b64_tr_b16 v[184:184+1], v202 offset:20480
    ds_read_b64_tr_b16 v[186:186+1], v202 offset:22528
    s_waitcnt lgkmcnt(6)
    v_mfma_f32_32x32x16_bf16 v[112:127], v[188:191], v[160:163], v[112:127]
    ds_read_b64_tr_b16 v[188:188+1], v203 offset:20480
    ds_read_b64_tr_b16 v[190:190+1], v203 offset:22528
    s_waitcnt lgkmcnt(6)
    v_mfma_f32_32x32x16_bf16 v[64:79], v[176:179], v[164:167], v[64:79]
    ds_read_b64_tr_b16 v[176:176+1], v200 offset:24576
    ds_read_b64_tr_b16 v[178:178+1], v200 offset:26624
    s_waitcnt lgkmcnt(6)
    v_mfma_f32_32x32x16_bf16 v[80:95], v[180:183], v[164:167], v[80:95]
    ds_read_b64_tr_b16 v[180:180+1], v201 offset:24576
    ds_read_b64_tr_b16 v[182:182+1], v201 offset:26624
    s_waitcnt lgkmcnt(6)
    v_mfma_f32_32x32x16_bf16 v[96:111], v[184:187], v[164:167], v[96:111]
    ds_read_b64_tr_b16 v[184:184+1], v202 offset:24576
    ds_read_b64_tr_b16 v[186:186+1], v202 offset:26624
    s_waitcnt lgkmcnt(6)
    v_mfma_f32_32x32x16_bf16 v[112:127], v[188:191], v[164:167], v[112:127]
    ds_read_b64_tr_b16 v[188:188+1], v203 offset:24576
    ds_read_b64_tr_b16 v[190:190+1], v203 offset:26624
    s_waitcnt lgkmcnt(6)
    v_mfma_f32_32x32x16_bf16 v[64:79], v[176:179], v[168:171], v[64:79]
    ds_read_b64_tr_b16 v[176:176+1], v200 offset:28672
    ds_read_b64_tr_b16 v[178:178+1], v200 offset:30720
    s_waitcnt lgkmcnt(6)
    v_mfma_f32_32x32x16_bf16 v[80:95], v[180:183], v[168:171], v[80:95]
    ds_read_b64_tr_b16 v[180:180+1], v201 offset:28672
    ds_read_b64_tr_b16 v[182:182+1], v201 offset:30720
    s_waitcnt lgkmcnt(6)
    v_mfma_f32_32x32x16_bf16 v[96:111], v[184:187], v[168:171], v[96:111]
    ds_read_b64_tr_b16 v[184:184+1], v202 offset:28672
    ds_read_b64_tr_b16 v[186:186+1], v202 offset:30720
    s_waitcnt lgkmcnt(6)
    v_mfma_f32_32x32x16_bf16 v[112:127], v[188:191], v[168:171], v[112:127]
    ds_read_b64_tr_b16 v[188:188+1], v203 offset:28672
    ds_read_b64_tr_b16 v[190:190+1], v203 offset:30720
    s_waitcnt lgkmcnt(6)
    v_mfma_f32_32x32x16_bf16 v[64:79], v[176:179], v[172:175], v[64:79]
    s_waitcnt lgkmcnt(4)
    v_mfma_f32_32x32x16_bf16 v[80:95], v[180:183], v[172:175], v[80:95]
    s_waitcnt lgkmcnt(2)
    v_mfma_f32_32x32x16_bf16 v[96:111], v[184:187], v[172:175], v[96:111]
    s_waitcnt lgkmcnt(0)
    v_mfma_f32_32x32x16_bf16 v[112:127], v[188:191], v[172:175], v[112:127]
    s_waitcnt vmcnt(8)
    s_barrier
    s_add_u32 m0, s44, 16384
    s_add_u32 s41, s2, 4
    s_and_b32 s41, s41, 7
    s_lshl_b32 s41, s41, 14
    s_add_u32 s40, s41, s44
    buffer_load_dwordx4 v220, s[28:31], s40 offen offset:0 lds
    s_add_u32 s41, s2, 4
    s_and_b32 s41, s41, 7
    s_lshl_b32 s41, s41, 14
    s_add_u32 s40, s41, s44
    buffer_load_dwordx4 v220, s[28:31], s40 offen offset:1024 lds
    s_add_u32 s41, s2, 4
    s_and_b32 s41, s41, 7
    s_lshl_b32 s41, s41, 14
    s_add_u32 s40, s41, s44
    buffer_load_dwordx4 v220, s[28:31], s40 offen offset:2048 lds
    s_add_u32 s41, s2, 4
    s_and_b32 s41, s41, 7
    s_lshl_b32 s41, s41, 14
    s_add_u32 s40, s41, s44
    buffer_load_dwordx4 v220, s[28:31], s40 offen offset:3072 lds
    ds_read_b128 v[176:176+3], v192 offset:32768
    ds_read_b128 v[180:180+3], v193 offset:32768
    ds_read_b128 v[184:184+3], v194 offset:32768
    ds_read_b128 v[188:188+3], v195 offset:32768
    s_waitcnt lgkmcnt(3)
    v_mfma_f32_32x32x16_bf16 v[128:143], v[176:179], v[32:35], 0
    ds_read_b128 v[176:176+3], v196 offset:32768
    s_waitcnt lgkmcnt(3)
    v_mfma_f32_32x32x16_bf16 v[128:143], v[180:183], v[36:39], v[128:143]
    ds_read_b128 v[180:180+3], v197 offset:32768
    s_waitcnt lgkmcnt(3)
    v_mfma_f32_32x32x16_bf16 v[128:143], v[184:187], v[40:43], v[128:143]
    ds_read_b128 v[184:184+3], v198 offset:32768
    s_waitcnt lgkmcnt(3)
    v_mfma_f32_32x32x16_bf16 v[128:143], v[188:191], v[44:47], v[128:143]
    ds_read_b128 v[188:188+3], v199 offset:32768
    s_waitcnt lgkmcnt(3)
    v_mfma_f32_32x32x16_bf16 v[128:143], v[176:179], v[48:51], v[128:143]
    ds_read_b128 v[176:176+3], v192 offset:40960
    s_waitcnt lgkmcnt(3)
    v_mfma_f32_32x32x16_bf16 v[128:143], v[180:183], v[52:55], v[128:143]
    ds_read_b128 v[180:180+3], v193 offset:40960
    s_waitcnt lgkmcnt(3)
    v_mfma_f32_32x32x16_bf16 v[128:143], v[184:187], v[56:59], v[128:143]
    ds_read_b128 v[184:184+3], v194 offset:40960
    s_waitcnt lgkmcnt(3)
    v_mfma_f32_32x32x16_bf16 v[128:143], v[188:191], v[60:63], v[128:143]
    ds_read_b128 v[188:188+3], v195 offset:40960
    s_waitcnt lgkmcnt(3)
    v_mfma_f32_32x32x16_bf16 v[144:159], v[176:179], v[32:35], 0
    ds_read_b128 v[176:176+3], v196 offset:40960
    s_waitcnt lgkmcnt(3)
    v_mfma_f32_32x32x16_bf16 v[144:159], v[180:183], v[36:39], v[144:159]
    ds_read_b128 v[180:180+3], v197 offset:40960
    s_waitcnt lgkmcnt(3)
    v_mfma_f32_32x32x16_bf16 v[144:159], v[184:187], v[40:43], v[144:159]
    ds_read_b128 v[184:184+3], v198 offset:40960
    s_waitcnt lgkmcnt(3)
    v_mfma_f32_32x32x16_bf16 v[144:159], v[188:191], v[44:47], v[144:159]
    ds_read_b128 v[188:188+3], v199 offset:40960
    s_waitcnt lgkmcnt(3)
    v_mfma_f32_32x32x16_bf16 v[144:159], v[176:179], v[48:51], v[144:159]
    s_waitcnt lgkmcnt(2)
    v_mfma_f32_32x32x16_bf16 v[144:159], v[180:183], v[52:55], v[144:159]
    s_waitcnt lgkmcnt(1)
    v_mfma_f32_32x32x16_bf16 v[144:159], v[184:187], v[56:59], v[144:159]
    s_waitcnt lgkmcnt(0)
    v_mfma_f32_32x32x16_bf16 v[144:159], v[188:191], v[60:63], v[144:159]
    s_nop 7
    s_nop 4
    v_max3_f32 v211, v128, v129, v209
    v_max3_f32 v211, v130, v131, v211
    v_max3_f32 v211, v132, v133, v211
    v_max3_f32 v211, v134, v135, v211
    v_max3_f32 v211, v136, v137, v211
    v_max3_f32 v211, v138, v139, v211
    v_max3_f32 v211, v140, v141, v211
    v_max3_f32 v211, v142, v143, v211
    v_max3_f32 v211, v144, v145, v211
    v_max3_f32 v211, v146, v147, v211
    v_max3_f32 v211, v148, v149, v211
    v_max3_f32 v211, v150, v151, v211
    v_max3_f32 v211, v152, v153, v211
    v_max3_f32 v211, v154, v155, v211
    v_max3_f32 v211, v156, v157, v211
    v_max3_f32 v211, v158, v159, v211
    v_mov_b32 v212, v211
    s_nop 1
    v_permlane32_swap_b32 v211, v212
    s_nop 1
    v_max_f32 v211, v211, v212
    v_sub_f32 v213, v209, v211
    v_exp_f32 v213, v213
    v_mov_b32 v209, v211
    v_sub_f32 v128, v128, v211
    v_exp_f32 v128, v128
    v_sub_f32 v129, v129, v211
    v_exp_f32 v129, v129
    v_sub_f32 v130, v130, v211
    v_exp_f32 v130, v130
    v_sub_f32 v131, v131, v211
    v_exp_f32 v131, v131
    v_sub_f32 v132, v132, v211
    v_exp_f32 v132, v132
    v_sub_f32 v133, v133, v211
    v_exp_f32 v133, v133
    v_sub_f32 v134, v134, v211
    v_exp_f32 v134, v134
    v_sub_f32 v135, v135, v211
    v_exp_f32 v135, v135
    v_sub_f32 v136, v136, v211
    v_exp_f32 v136, v136
    v_sub_f32 v137, v137, v211
    v_exp_f32 v137, v137
    v_sub_f32 v138, v138, v211
    v_exp_f32 v138, v138
    v_sub_f32 v139, v139, v211
    v_exp_f32 v139, v139
    v_sub_f32 v140, v140, v211
    v_exp_f32 v140, v140
    v_sub_f32 v141, v141, v211
    v_exp_f32 v141, v141
    v_sub_f32 v142, v142, v211
    v_exp_f32 v142, v142
    v_sub_f32 v143, v143, v211
    v_exp_f32 v143, v143
    v_sub_f32 v144, v144, v211
    v_exp_f32 v144, v144
    v_sub_f32 v145, v145, v211
    v_exp_f32 v145, v145
    v_sub_f32 v146, v146, v211
    v_exp_f32 v146, v146
    v_sub_f32 v147, v147, v211
    v_exp_f32 v147, v147
    v_sub_f32 v148, v148, v211
    v_exp_f32 v148, v148
    v_sub_f32 v149, v149, v211
    v_exp_f32 v149, v149
    v_sub_f32 v150, v150, v211
    v_exp_f32 v150, v150
    v_sub_f32 v151, v151, v211
    v_exp_f32 v151, v151
    v_sub_f32 v152, v152, v211
    v_exp_f32 v152, v152
    v_sub_f32 v153, v153, v211
    v_exp_f32 v153, v153
    v_sub_f32 v154, v154, v211
    v_exp_f32 v154, v154
    v_sub_f32 v155, v155, v211
    v_exp_f32 v155, v155
    v_sub_f32 v156, v156, v211
    v_exp_f32 v156, v156
    v_sub_f32 v157, v157, v211
    v_exp_f32 v157, v157
    v_sub_f32 v158, v158, v211
    v_exp_f32 v158, v158
    v_sub_f32 v159, v159, v211
    v_exp_f32 v159, v159
    v_mul_f32 v210, v210, v213
    v_mul_f32 v64, v64, v213
    v_mul_f32 v65, v65, v213
    v_mul_f32 v66, v66, v213
    v_mul_f32 v67, v67, v213
    v_mul_f32 v68, v68, v213
    v_mul_f32 v69, v69, v213
    v_mul_f32 v70, v70, v213
    v_mul_f32 v71, v71, v213
    v_mul_f32 v72, v72, v213
    v_mul_f32 v73, v73, v213
    v_mul_f32 v74, v74, v213
    v_mul_f32 v75, v75, v213
    v_mul_f32 v76, v76, v213
    v_mul_f32 v77, v77, v213
    v_mul_f32 v78, v78, v213
    v_mul_f32 v79, v79, v213
    v_mul_f32 v80, v80, v213
    v_mul_f32 v81, v81, v213
    v_mul_f32 v82, v82, v213
    v_mul_f32 v83, v83, v213
    v_mul_f32 v84, v84, v213
    v_mul_f32 v85, v85, v213
    v_mul_f32 v86, v86, v213
    v_mul_f32 v87, v87, v213
    v_mul_f32 v88, v88, v213
    v_mul_f32 v89, v89, v213
    v_mul_f32 v90, v90, v213
    v_mul_f32 v91, v91, v213
    v_mul_f32 v92, v92, v213
    v_mul_f32 v93, v93, v213
    v_mul_f32 v94, v94, v213
    v_mul_f32 v95, v95, v213
    v_mul_f32 v96, v96, v213
    v_mul_f32 v97, v97, v213
    v_mul_f32 v98, v98, v213
    v_mul_f32 v99, v99, v213
    v_mul_f32 v100, v100, v213
    v_mul_f32 v101, v101, v213
    v_mul_f32 v102, v102, v213
    v_mul_f32 v103, v103, v213
    v_mul_f32 v104, v104, v213
    v_mul_f32 v105, v105, v213
    v_mul_f32 v106, v106, v213
    v_mul_f32 v107, v107, v213
    v_mul_f32 v108, v108, v213
    v_mul_f32 v109, v109, v213
    v_mul_f32 v110, v110, v213
    v_mul_f32 v111, v111, v213
    v_mul_f32 v112, v112, v213
    v_mul_f32 v113, v113, v213
    v_mul_f32 v114, v114, v213
    v_mul_f32 v115, v115, v213
    v_mul_f32 v116, v116, v213
    v_mul_f32 v117, v117, v213
    v_mul_f32 v118, v118, v213
    v_mul_f32 v119, v119, v213
    v_mul_f32 v120, v120, v213
    v_mul_f32 v121, v121, v213
    v_mul_f32 v122, v122, v213
    v_mul_f32 v123, v123, v213
    v_mul_f32 v124, v124, v213
    v_mul_f32 v125, v125, v213
    v_mul_f32 v126, v126, v213
    v_mul_f32 v127, v127, v213
    v_add_f32 v210, v210, v128
    v_add_f32 v210, v210, v129
    v_add_f32 v210, v210, v130
    v_add_f32 v210, v210, v131
    v_add_f32 v210, v210, v132
    v_add_f32 v210, v210, v133
    v_add_f32 v210, v210, v134
    v_add_f32 v210, v210, v135
    v_add_f32 v210, v210, v136
    v_add_f32 v210, v210, v137
    v_add_f32 v210, v210, v138
    v_add_f32 v210, v210, v139
    v_add_f32 v210, v210, v140
    v_add_f32 v210, v210, v141
    v_add_f32 v210, v210, v142
    v_add_f32 v210, v210, v143
    v_add_f32 v210, v210, v144
    v_add_f32 v210, v210, v145
    v_add_f32 v210, v210, v146
    v_add_f32 v210, v210, v147
    v_add_f32 v210, v210, v148
    v_add_f32 v210, v210, v149
    v_add_f32 v210, v210, v150
    v_add_f32 v210, v210, v151
    v_add_f32 v210, v210, v152
    v_add_f32 v210, v210, v153
    v_add_f32 v210, v210, v154
    v_add_f32 v210, v210, v155
    v_add_f32 v210, v210, v156
    v_add_f32 v210, v210, v157
    v_add_f32 v210, v210, v158
    v_add_f32 v210, v210, v159
    v_cvt_pk_bf16_f32 v160, v128, v129
    v_cvt_pk_bf16_f32 v161, v130, v131
    v_cvt_pk_bf16_f32 v162, v132, v133
    v_cvt_pk_bf16_f32 v163, v134, v135
    v_cvt_pk_bf16_f32 v164, v136, v137
    v_cvt_pk_bf16_f32 v165, v138, v139
    v_cvt_pk_bf16_f32 v166, v140, v141
    v_cvt_pk_bf16_f32 v167, v142, v143
    v_cvt_pk_bf16_f32 v168, v144, v145
    v_cvt_pk_bf16_f32 v169, v146, v147
    v_cvt_pk_bf16_f32 v170, v148, v149
    v_cvt_pk_bf16_f32 v171, v150, v151
    v_cvt_pk_bf16_f32 v172, v152, v153
    v_cvt_pk_bf16_f32 v173, v154, v155
    v_cvt_pk_bf16_f32 v174, v156, v157
    v_cvt_pk_bf16_f32 v175, v158, v159
    s_waitcnt vmcnt(8)
    s_barrier
    s_add_u32 m0, s44, 32768
    s_add_u32 s41, s2, 5
    s_and_b32 s41, s41, 7
    s_lshl_b32 s41, s41, 14
    s_add_u32 s40, s41, s44
    buffer_load_dwordx4 v216, s[24:27], s40 offen offset:0 lds
    s_add_u32 s41, s2, 5
    s_and_b32 s41, s41, 7
    s_lshl_b32 s41, s41, 14
    s_add_u32 s40, s41, s44
    buffer_load_dwordx4 v217, s[24:27], s40 offen offset:1024 lds
    s_add_u32 s41, s2, 5
    s_and_b32 s41, s41, 7
    s_lshl_b32 s41, s41, 14
    s_add_u32 s40, s41, s44
    buffer_load_dwordx4 v218, s[24:27], s40 offen offset:2048 lds
    s_add_u32 s41, s2, 5
    s_and_b32 s41, s41, 7
    s_lshl_b32 s41, s41, 14
    s_add_u32 s40, s41, s44
    buffer_load_dwordx4 v219, s[24:27], s40 offen offset:3072 lds
    ds_read_b64_tr_b16 v[176:176+1], v200 offset:49152
    ds_read_b64_tr_b16 v[178:178+1], v200 offset:51200
    ds_read_b64_tr_b16 v[180:180+1], v201 offset:49152
    ds_read_b64_tr_b16 v[182:182+1], v201 offset:51200
    ds_read_b64_tr_b16 v[184:184+1], v202 offset:49152
    ds_read_b64_tr_b16 v[186:186+1], v202 offset:51200
    ds_read_b64_tr_b16 v[188:188+1], v203 offset:49152
    ds_read_b64_tr_b16 v[190:190+1], v203 offset:51200
    s_waitcnt lgkmcnt(6)
    v_mfma_f32_32x32x16_bf16 v[64:79], v[176:179], v[160:163], v[64:79]
    ds_read_b64_tr_b16 v[176:176+1], v200 offset:53248
    ds_read_b64_tr_b16 v[178:178+1], v200 offset:55296
    s_waitcnt lgkmcnt(6)
    v_mfma_f32_32x32x16_bf16 v[80:95], v[180:183], v[160:163], v[80:95]
    ds_read_b64_tr_b16 v[180:180+1], v201 offset:53248
    ds_read_b64_tr_b16 v[182:182+1], v201 offset:55296
    s_waitcnt lgkmcnt(6)
    v_mfma_f32_32x32x16_bf16 v[96:111], v[184:187], v[160:163], v[96:111]
    ds_read_b64_tr_b16 v[184:184+1], v202 offset:53248
    ds_read_b64_tr_b16 v[186:186+1], v202 offset:55296
    s_waitcnt lgkmcnt(6)
    v_mfma_f32_32x32x16_bf16 v[112:127], v[188:191], v[160:163], v[112:127]
    ds_read_b64_tr_b16 v[188:188+1], v203 offset:53248
    ds_read_b64_tr_b16 v[190:190+1], v203 offset:55296
    s_waitcnt lgkmcnt(6)
    v_mfma_f32_32x32x16_bf16 v[64:79], v[176:179], v[164:167], v[64:79]
    ds_read_b64_tr_b16 v[176:176+1], v200 offset:57344
    ds_read_b64_tr_b16 v[178:178+1], v200 offset:59392
    s_waitcnt lgkmcnt(6)
    v_mfma_f32_32x32x16_bf16 v[80:95], v[180:183], v[164:167], v[80:95]
    ds_read_b64_tr_b16 v[180:180+1], v201 offset:57344
    ds_read_b64_tr_b16 v[182:182+1], v201 offset:59392
    s_waitcnt lgkmcnt(6)
    v_mfma_f32_32x32x16_bf16 v[96:111], v[184:187], v[164:167], v[96:111]
    ds_read_b64_tr_b16 v[184:184+1], v202 offset:57344
    ds_read_b64_tr_b16 v[186:186+1], v202 offset:59392
    s_waitcnt lgkmcnt(6)
    v_mfma_f32_32x32x16_bf16 v[112:127], v[188:191], v[164:167], v[112:127]
    ds_read_b64_tr_b16 v[188:188+1], v203 offset:57344
    ds_read_b64_tr_b16 v[190:190+1], v203 offset:59392
    s_waitcnt lgkmcnt(6)
    v_mfma_f32_32x32x16_bf16 v[64:79], v[176:179], v[168:171], v[64:79]
    ds_read_b64_tr_b16 v[176:176+1], v200 offset:61440
    ds_read_b64_tr_b16 v[178:178+1], v200 offset:63488
    s_waitcnt lgkmcnt(6)
    v_mfma_f32_32x32x16_bf16 v[80:95], v[180:183], v[168:171], v[80:95]
    ds_read_b64_tr_b16 v[180:180+1], v201 offset:61440
    ds_read_b64_tr_b16 v[182:182+1], v201 offset:63488
    s_waitcnt lgkmcnt(6)
    v_mfma_f32_32x32x16_bf16 v[96:111], v[184:187], v[168:171], v[96:111]
    ds_read_b64_tr_b16 v[184:184+1], v202 offset:61440
    ds_read_b64_tr_b16 v[186:186+1], v202 offset:63488
    s_waitcnt lgkmcnt(6)
    v_mfma_f32_32x32x16_bf16 v[112:127], v[188:191], v[168:171], v[112:127]
    ds_read_b64_tr_b16 v[188:188+1], v203 offset:61440
    ds_read_b64_tr_b16 v[190:190+1], v203 offset:63488
    s_waitcnt lgkmcnt(6)
    v_mfma_f32_32x32x16_bf16 v[64:79], v[176:179], v[172:175], v[64:79]
    s_waitcnt lgkmcnt(4)
    v_mfma_f32_32x32x16_bf16 v[80:95], v[180:183], v[172:175], v[80:95]
    s_waitcnt lgkmcnt(2)
    v_mfma_f32_32x32x16_bf16 v[96:111], v[184:187], v[172:175], v[96:111]
    s_waitcnt lgkmcnt(0)
    v_mfma_f32_32x32x16_bf16 v[112:127], v[188:191], v[172:175], v[112:127]
    s_waitcnt vmcnt(8)
    s_barrier
    s_add_u32 m0, s44, 49152
    s_add_u32 s41, s2, 5
    s_and_b32 s41, s41, 7
    s_lshl_b32 s41, s41, 14
    s_add_u32 s40, s41, s44
    buffer_load_dwordx4 v220, s[28:31], s40 offen offset:0 lds
    s_add_u32 s41, s2, 5
    s_and_b32 s41, s41, 7
    s_lshl_b32 s41, s41, 14
    s_add_u32 s40, s41, s44
    buffer_load_dwordx4 v220, s[28:31], s40 offen offset:1024 lds
    s_add_u32 s41, s2, 5
    s_and_b32 s41, s41, 7
    s_lshl_b32 s41, s41, 14
    s_add_u32 s40, s41, s44
    buffer_load_dwordx4 v220, s[28:31], s40 offen offset:2048 lds
    s_add_u32 s41, s2, 5
    s_and_b32 s41, s41, 7
    s_lshl_b32 s41, s41, 14
    s_add_u32 s40, s41, s44
    buffer_load_dwordx4 v220, s[28:31], s40 offen offset:3072 lds
    ds_read_b128 v[176:176+3], v192 offset:0
    ds_read_b128 v[180:180+3], v193 offset:0
    ds_read_b128 v[184:184+3], v194 offset:0
    ds_read_b128 v[188:188+3], v195 offset:0
    s_waitcnt lgkmcnt(3)
    v_mfma_f32_32x32x16_bf16 v[128:143], v[176:179], v[32:35], 0
    ds_read_b128 v[176:176+3], v196 offset:0
    s_waitcnt lgkmcnt(3)
    v_mfma_f32_32x32x16_bf16 v[128:143], v[180:183], v[36:39], v[128:143]
    ds_read_b128 v[180:180+3], v197 offset:0
    s_waitcnt lgkmcnt(3)
    v_mfma_f32_32x32x16_bf16 v[128:143], v[184:187], v[40:43], v[128:143]
    ds_read_b128 v[184:184+3], v198 offset:0
    s_waitcnt lgkmcnt(3)
    v_mfma_f32_32x32x16_bf16 v[128:143], v[188:191], v[44:47], v[128:143]
    ds_read_b128 v[188:188+3], v199 offset:0
    s_waitcnt lgkmcnt(3)
    v_mfma_f32_32x32x16_bf16 v[128:143], v[176:179], v[48:51], v[128:143]
    ds_read_b128 v[176:176+3], v192 offset:8192
    s_waitcnt lgkmcnt(3)
    v_mfma_f32_32x32x16_bf16 v[128:143], v[180:183], v[52:55], v[128:143]
    ds_read_b128 v[180:180+3], v193 offset:8192
    s_waitcnt lgkmcnt(3)
    v_mfma_f32_32x32x16_bf16 v[128:143], v[184:187], v[56:59], v[128:143]
    ds_read_b128 v[184:184+3], v194 offset:8192
    s_waitcnt lgkmcnt(3)
    v_mfma_f32_32x32x16_bf16 v[128:143], v[188:191], v[60:63], v[128:143]
    ds_read_b128 v[188:188+3], v195 offset:8192
    s_waitcnt lgkmcnt(3)
    v_mfma_f32_32x32x16_bf16 v[144:159], v[176:179], v[32:35], 0
    ds_read_b128 v[176:176+3], v196 offset:8192
    s_waitcnt lgkmcnt(3)
    v_mfma_f32_32x32x16_bf16 v[144:159], v[180:183], v[36:39], v[144:159]
    ds_read_b128 v[180:180+3], v197 offset:8192
    s_waitcnt lgkmcnt(3)
    v_mfma_f32_32x32x16_bf16 v[144:159], v[184:187], v[40:43], v[144:159]
    ds_read_b128 v[184:184+3], v198 offset:8192
    s_waitcnt lgkmcnt(3)
    v_mfma_f32_32x32x16_bf16 v[144:159], v[188:191], v[44:47], v[144:159]
    ds_read_b128 v[188:188+3], v199 offset:8192
    s_waitcnt lgkmcnt(3)
    v_mfma_f32_32x32x16_bf16 v[144:159], v[176:179], v[48:51], v[144:159]
    s_waitcnt lgkmcnt(2)
    v_mfma_f32_32x32x16_bf16 v[144:159], v[180:183], v[52:55], v[144:159]
    s_waitcnt lgkmcnt(1)
    v_mfma_f32_32x32x16_bf16 v[144:159], v[184:187], v[56:59], v[144:159]
    s_waitcnt lgkmcnt(0)
    v_mfma_f32_32x32x16_bf16 v[144:159], v[188:191], v[60:63], v[144:159]
    s_nop 7
    s_nop 4
    v_max3_f32 v211, v128, v129, v209
    v_max3_f32 v211, v130, v131, v211
    v_max3_f32 v211, v132, v133, v211
    v_max3_f32 v211, v134, v135, v211
    v_max3_f32 v211, v136, v137, v211
    v_max3_f32 v211, v138, v139, v211
    v_max3_f32 v211, v140, v141, v211
    v_max3_f32 v211, v142, v143, v211
    v_max3_f32 v211, v144, v145, v211
    v_max3_f32 v211, v146, v147, v211
    v_max3_f32 v211, v148, v149, v211
    v_max3_f32 v211, v150, v151, v211
    v_max3_f32 v211, v152, v153, v211
    v_max3_f32 v211, v154, v155, v211
    v_max3_f32 v211, v156, v157, v211
    v_max3_f32 v211, v158, v159, v211
    v_mov_b32 v212, v211
    s_nop 1
    v_permlane32_swap_b32 v211, v212
    s_nop 1
    v_max_f32 v211, v211, v212
    v_sub_f32 v213, v209, v211
    v_exp_f32 v213, v213
    v_mov_b32 v209, v211
    v_sub_f32 v128, v128, v211
    v_exp_f32 v128, v128
    v_sub_f32 v129, v129, v211
    v_exp_f32 v129, v129
    v_sub_f32 v130, v130, v211
    v_exp_f32 v130, v130
    v_sub_f32 v131, v131, v211
    v_exp_f32 v131, v131
    v_sub_f32 v132, v132, v211
    v_exp_f32 v132, v132
    v_sub_f32 v133, v133, v211
    v_exp_f32 v133, v133
    v_sub_f32 v134, v134, v211
    v_exp_f32 v134, v134
    v_sub_f32 v135, v135, v211
    v_exp_f32 v135, v135
    v_sub_f32 v136, v136, v211
    v_exp_f32 v136, v136
    v_sub_f32 v137, v137, v211
    v_exp_f32 v137, v137
    v_sub_f32 v138, v138, v211
    v_exp_f32 v138, v138
    v_sub_f32 v139, v139, v211
    v_exp_f32 v139, v139
    v_sub_f32 v140, v140, v211
    v_exp_f32 v140, v140
    v_sub_f32 v141, v141, v211
    v_exp_f32 v141, v141
    v_sub_f32 v142, v142, v211
    v_exp_f32 v142, v142
    v_sub_f32 v143, v143, v211
    v_exp_f32 v143, v143
    v_sub_f32 v144, v144, v211
    v_exp_f32 v144, v144
    v_sub_f32 v145, v145, v211
    v_exp_f32 v145, v145
    v_sub_f32 v146, v146, v211
    v_exp_f32 v146, v146
    v_sub_f32 v147, v147, v211
    v_exp_f32 v147, v147
    v_sub_f32 v148, v148, v211
    v_exp_f32 v148, v148
    v_sub_f32 v149, v149, v211
    v_exp_f32 v149, v149
    v_sub_f32 v150, v150, v211
    v_exp_f32 v150, v150
    v_sub_f32 v151, v151, v211
    v_exp_f32 v151, v151
    v_sub_f32 v152, v152, v211
    v_exp_f32 v152, v152
    v_sub_f32 v153, v153, v211
    v_exp_f32 v153, v153
    v_sub_f32 v154, v154, v211
    v_exp_f32 v154, v154
    v_sub_f32 v155, v155, v211
    v_exp_f32 v155, v155
    v_sub_f32 v156, v156, v211
    v_exp_f32 v156, v156
    v_sub_f32 v157, v157, v211
    v_exp_f32 v157, v157
    v_sub_f32 v158, v158, v211
    v_exp_f32 v158, v158
    v_sub_f32 v159, v159, v211
    v_exp_f32 v159, v159
    v_mul_f32 v210, v210, v213
    v_mul_f32 v64, v64, v213
    v_mul_f32 v65, v65, v213
    v_mul_f32 v66, v66, v213
    v_mul_f32 v67, v67, v213
    v_mul_f32 v68, v68, v213
    v_mul_f32 v69, v69, v213
    v_mul_f32 v70, v70, v213
    v_mul_f32 v71, v71, v213
    v_mul_f32 v72, v72, v213
    v_mul_f32 v73, v73, v213
    v_mul_f32 v74, v74, v213
    v_mul_f32 v75, v75, v213
    v_mul_f32 v76, v76, v213
    v_mul_f32 v77, v77, v213
    v_mul_f32 v78, v78, v213
    v_mul_f32 v79, v79, v213
    v_mul_f32 v80, v80, v213
    v_mul_f32 v81, v81, v213
    v_mul_f32 v82, v82, v213
    v_mul_f32 v83, v83, v213
    v_mul_f32 v84, v84, v213
    v_mul_f32 v85, v85, v213
    v_mul_f32 v86, v86, v213
    v_mul_f32 v87, v87, v213
    v_mul_f32 v88, v88, v213
    v_mul_f32 v89, v89, v213
    v_mul_f32 v90, v90, v213
    v_mul_f32 v91, v91, v213
    v_mul_f32 v92, v92, v213
    v_mul_f32 v93, v93, v213
    v_mul_f32 v94, v94, v213
    v_mul_f32 v95, v95, v213
    v_mul_f32 v96, v96, v213
    v_mul_f32 v97, v97, v213
    v_mul_f32 v98, v98, v213
    v_mul_f32 v99, v99, v213
    v_mul_f32 v100, v100, v213
    v_mul_f32 v101, v101, v213
    v_mul_f32 v102, v102, v213
    v_mul_f32 v103, v103, v213
    v_mul_f32 v104, v104, v213
    v_mul_f32 v105, v105, v213
    v_mul_f32 v106, v106, v213
    v_mul_f32 v107, v107, v213
    v_mul_f32 v108, v108, v213
    v_mul_f32 v109, v109, v213
    v_mul_f32 v110, v110, v213
    v_mul_f32 v111, v111, v213
    v_mul_f32 v112, v112, v213
    v_mul_f32 v113, v113, v213
    v_mul_f32 v114, v114, v213
    v_mul_f32 v115, v115, v213
    v_mul_f32 v116, v116, v213
    v_mul_f32 v117, v117, v213
    v_mul_f32 v118, v118, v213
    v_mul_f32 v119, v119, v213
    v_mul_f32 v120, v120, v213
    v_mul_f32 v121, v121, v213
    v_mul_f32 v122, v122, v213
    v_mul_f32 v123, v123, v213
    v_mul_f32 v124, v124, v213
    v_mul_f32 v125, v125, v213
    v_mul_f32 v126, v126, v213
    v_mul_f32 v127, v127, v213
    v_add_f32 v210, v210, v128
    v_add_f32 v210, v210, v129
    v_add_f32 v210, v210, v130
    v_add_f32 v210, v210, v131
    v_add_f32 v210, v210, v132
    v_add_f32 v210, v210, v133
    v_add_f32 v210, v210, v134
    v_add_f32 v210, v210, v135
    v_add_f32 v210, v210, v136
    v_add_f32 v210, v210, v137
    v_add_f32 v210, v210, v138
    v_add_f32 v210, v210, v139
    v_add_f32 v210, v210, v140
    v_add_f32 v210, v210, v141
    v_add_f32 v210, v210, v142
    v_add_f32 v210, v210, v143
    v_add_f32 v210, v210, v144
    v_add_f32 v210, v210, v145
    v_add_f32 v210, v210, v146
    v_add_f32 v210, v210, v147
    v_add_f32 v210, v210, v148
    v_add_f32 v210, v210, v149
    v_add_f32 v210, v210, v150
    v_add_f32 v210, v210, v151
    v_add_f32 v210, v210, v152
    v_add_f32 v210, v210, v153
    v_add_f32 v210, v210, v154
    v_add_f32 v210, v210, v155
    v_add_f32 v210, v210, v156
    v_add_f32 v210, v210, v157
    v_add_f32 v210, v210, v158
    v_add_f32 v210, v210, v159
    v_cvt_pk_bf16_f32 v160, v128, v129
    v_cvt_pk_bf16_f32 v161, v130, v131
    v_cvt_pk_bf16_f32 v162, v132, v133
    v_cvt_pk_bf16_f32 v163, v134, v135
    v_cvt_pk_bf16_f32 v164, v136, v137
    v_cvt_pk_bf16_f32 v165, v138, v139
    v_cvt_pk_bf16_f32 v166, v140, v141
    v_cvt_pk_bf16_f32 v167, v142, v143
    v_cvt_pk_bf16_f32 v168, v144, v145
    v_cvt_pk_bf16_f32 v169, v146, v147
    v_cvt_pk_bf16_f32 v170, v148, v149
    v_cvt_pk_bf16_f32 v171, v150, v151
    v_cvt_pk_bf16_f32 v172, v152, v153
    v_cvt_pk_bf16_f32 v173, v154, v155
    v_cvt_pk_bf16_f32 v174, v156, v157
    v_cvt_pk_bf16_f32 v175, v158, v159
    s_waitcnt vmcnt(8)
    s_barrier
    s_add_u32 m0, s44, 0
    s_add_u32 s41, s2, 6
    s_and_b32 s41, s41, 7
    s_lshl_b32 s41, s41, 14
    s_add_u32 s40, s41, s44
    buffer_load_dwordx4 v216, s[24:27], s40 offen offset:0 lds
    s_add_u32 s41, s2, 6
    s_and_b32 s41, s41, 7
    s_lshl_b32 s41, s41, 14
    s_add_u32 s40, s41, s44
    buffer_load_dwordx4 v217, s[24:27], s40 offen offset:1024 lds
    s_add_u32 s41, s2, 6
    s_and_b32 s41, s41, 7
    s_lshl_b32 s41, s41, 14
    s_add_u32 s40, s41, s44
    buffer_load_dwordx4 v218, s[24:27], s40 offen offset:2048 lds
    s_add_u32 s41, s2, 6
    s_and_b32 s41, s41, 7
    s_lshl_b32 s41, s41, 14
    s_add_u32 s40, s41, s44
    buffer_load_dwordx4 v219, s[24:27], s40 offen offset:3072 lds
    ds_read_b64_tr_b16 v[176:176+1], v200 offset:16384
    ds_read_b64_tr_b16 v[178:178+1], v200 offset:18432
    ds_read_b64_tr_b16 v[180:180+1], v201 offset:16384
    ds_read_b64_tr_b16 v[182:182+1], v201 offset:18432
    ds_read_b64_tr_b16 v[184:184+1], v202 offset:16384
    ds_read_b64_tr_b16 v[186:186+1], v202 offset:18432
    ds_read_b64_tr_b16 v[188:188+1], v203 offset:16384
    ds_read_b64_tr_b16 v[190:190+1], v203 offset:18432
    s_waitcnt lgkmcnt(6)
    v_mfma_f32_32x32x16_bf16 v[64:79], v[176:179], v[160:163], v[64:79]
    ds_read_b64_tr_b16 v[176:176+1], v200 offset:20480
    ds_read_b64_tr_b16 v[178:178+1], v200 offset:22528
    s_waitcnt lgkmcnt(6)
    v_mfma_f32_32x32x16_bf16 v[80:95], v[180:183], v[160:163], v[80:95]
    ds_read_b64_tr_b16 v[180:180+1], v201 offset:20480
    ds_read_b64_tr_b16 v[182:182+1], v201 offset:22528
    s_waitcnt lgkmcnt(6)
    v_mfma_f32_32x32x16_bf16 v[96:111], v[184:187], v[160:163], v[96:111]
    ds_read_b64_tr_b16 v[184:184+1], v202 offset:20480
    ds_read_b64_tr_b16 v[186:186+1], v202 offset:22528
    s_waitcnt lgkmcnt(6)
    v_mfma_f32_32x32x16_bf16 v[112:127], v[188:191], v[160:163], v[112:127]
    ds_read_b64_tr_b16 v[188:188+1], v203 offset:20480
    ds_read_b64_tr_b16 v[190:190+1], v203 offset:22528
    s_waitcnt lgkmcnt(6)
    v_mfma_f32_32x32x16_bf16 v[64:79], v[176:179], v[164:167], v[64:79]
    ds_read_b64_tr_b16 v[176:176+1], v200 offset:24576
    ds_read_b64_tr_b16 v[178:178+1], v200 offset:26624
    s_waitcnt lgkmcnt(6)
    v_mfma_f32_32x32x16_bf16 v[80:95], v[180:183], v[164:167], v[80:95]
    ds_read_b64_tr_b16 v[180:180+1], v201 offset:24576
    ds_read_b64_tr_b16 v[182:182+1], v201 offset:26624
    s_waitcnt lgkmcnt(6)
    v_mfma_f32_32x32x16_bf16 v[96:111], v[184:187], v[164:167], v[96:111]
    ds_read_b64_tr_b16 v[184:184+1], v202 offset:24576
    ds_read_b64_tr_b16 v[186:186+1], v202 offset:26624
    s_waitcnt lgkmcnt(6)
    v_mfma_f32_32x32x16_bf16 v[112:127], v[188:191], v[164:167], v[112:127]
    ds_read_b64_tr_b16 v[188:188+1], v203 offset:24576
    ds_read_b64_tr_b16 v[190:190+1], v203 offset:26624
    s_waitcnt lgkmcnt(6)
    v_mfma_f32_32x32x16_bf16 v[64:79], v[176:179], v[168:171], v[64:79]
    ds_read_b64_tr_b16 v[176:176+1], v200 offset:28672
    ds_read_b64_tr_b16 v[178:178+1], v200 offset:30720
    s_waitcnt lgkmcnt(6)
    v_mfma_f32_32x32x16_bf16 v[80:95], v[180:183], v[168:171], v[80:95]
    ds_read_b64_tr_b16 v[180:180+1], v201 offset:28672
    ds_read_b64_tr_b16 v[182:182+1], v201 offset:30720
    s_waitcnt lgkmcnt(6)
    v_mfma_f32_32x32x16_bf16 v[96:111], v[184:187], v[168:171], v[96:111]
    ds_read_b64_tr_b16 v[184:184+1], v202 offset:28672
    ds_read_b64_tr_b16 v[186:186+1], v202 offset:30720
    s_waitcnt lgkmcnt(6)
    v_mfma_f32_32x32x16_bf16 v[112:127], v[188:191], v[168:171], v[112:127]
    ds_read_b64_tr_b16 v[188:188+1], v203 offset:28672
    ds_read_b64_tr_b16 v[190:190+1], v203 offset:30720
    s_waitcnt lgkmcnt(6)
    v_mfma_f32_32x32x16_bf16 v[64:79], v[176:179], v[172:175], v[64:79]
    s_waitcnt lgkmcnt(4)
    v_mfma_f32_32x32x16_bf16 v[80:95], v[180:183], v[172:175], v[80:95]
    s_waitcnt lgkmcnt(2)
    v_mfma_f32_32x32x16_bf16 v[96:111], v[184:187], v[172:175], v[96:111]
    s_waitcnt lgkmcnt(0)
    v_mfma_f32_32x32x16_bf16 v[112:127], v[188:191], v[172:175], v[112:127]
    s_waitcnt vmcnt(8)
    s_barrier
    s_add_u32 m0, s44, 16384
    s_add_u32 s41, s2, 6
    s_and_b32 s41, s41, 7
    s_lshl_b32 s41, s41, 14
    s_add_u32 s40, s41, s44
    buffer_load_dwordx4 v220, s[28:31], s40 offen offset:0 lds
    s_add_u32 s41, s2, 6
    s_and_b32 s41, s41, 7
    s_lshl_b32 s41, s41, 14
    s_add_u32 s40, s41, s44
    buffer_load_dwordx4 v220, s[28:31], s40 offen offset:1024 lds
    s_add_u32 s41, s2, 6
    s_and_b32 s41, s41, 7
    s_lshl_b32 s41, s41, 14
    s_add_u32 s40, s41, s44
    buffer_load_dwordx4 v220, s[28:31], s40 offen offset:2048 lds
    s_add_u32 s41, s2, 6
    s_and_b32 s41, s41, 7
    s_lshl_b32 s41, s41, 14
    s_add_u32 s40, s41, s44
    buffer_load_dwordx4 v220, s[28:31], s40 offen offset:3072 lds
    ds_read_b128 v[176:176+3], v192 offset:32768
    ds_read_b128 v[180:180+3], v193 offset:32768
    ds_read_b128 v[184:184+3], v194 offset:32768
    ds_read_b128 v[188:188+3], v195 offset:32768
    s_waitcnt lgkmcnt(3)
    v_mfma_f32_32x32x16_bf16 v[128:143], v[176:179], v[32:35], 0
    ds_read_b128 v[176:176+3], v196 offset:32768
    s_waitcnt lgkmcnt(3)
    v_mfma_f32_32x32x16_bf16 v[128:143], v[180:183], v[36:39], v[128:143]
    ds_read_b128 v[180:180+3], v197 offset:32768
    s_waitcnt lgkmcnt(3)
    v_mfma_f32_32x32x16_bf16 v[128:143], v[184:187], v[40:43], v[128:143]
    ds_read_b128 v[184:184+3], v198 offset:32768
    s_waitcnt lgkmcnt(3)
    v_mfma_f32_32x32x16_bf16 v[128:143], v[188:191], v[44:47], v[128:143]
    ds_read_b128 v[188:188+3], v199 offset:32768
    s_waitcnt lgkmcnt(3)
    v_mfma_f32_32x32x16_bf16 v[128:143], v[176:179], v[48:51], v[128:143]
    ds_read_b128 v[176:176+3], v192 offset:40960
    s_waitcnt lgkmcnt(3)
    v_mfma_f32_32x32x16_bf16 v[128:143], v[180:183], v[52:55], v[128:143]
    ds_read_b128 v[180:180+3], v193 offset:40960
    s_waitcnt lgkmcnt(3)
    v_mfma_f32_32x32x16_bf16 v[128:143], v[184:187], v[56:59], v[128:143]
    ds_read_b128 v[184:184+3], v194 offset:40960
    s_waitcnt lgkmcnt(3)
    v_mfma_f32_32x32x16_bf16 v[128:143], v[188:191], v[60:63], v[128:143]
    ds_read_b128 v[188:188+3], v195 offset:40960
    s_waitcnt lgkmcnt(3)
    v_mfma_f32_32x32x16_bf16 v[144:159], v[176:179], v[32:35], 0
    ds_read_b128 v[176:176+3], v196 offset:40960
    s_waitcnt lgkmcnt(3)
    v_mfma_f32_32x32x16_bf16 v[144:159], v[180:183], v[36:39], v[144:159]
    ds_read_b128 v[180:180+3], v197 offset:40960
    s_waitcnt lgkmcnt(3)
    v_mfma_f32_32x32x16_bf16 v[144:159], v[184:187], v[40:43], v[144:159]
    ds_read_b128 v[184:184+3], v198 offset:40960
    s_waitcnt lgkmcnt(3)
    v_mfma_f32_32x32x16_bf16 v[144:159], v[188:191], v[44:47], v[144:159]
    ds_read_b128 v[188:188+3], v199 offset:40960
    s_waitcnt lgkmcnt(3)
    v_mfma_f32_32x32x16_bf16 v[144:159], v[176:179], v[48:51], v[144:159]
    s_waitcnt lgkmcnt(2)
    v_mfma_f32_32x32x16_bf16 v[144:159], v[180:183], v[52:55], v[144:159]
    s_waitcnt lgkmcnt(1)
    v_mfma_f32_32x32x16_bf16 v[144:159], v[184:187], v[56:59], v[144:159]
    s_waitcnt lgkmcnt(0)
    v_mfma_f32_32x32x16_bf16 v[144:159], v[188:191], v[60:63], v[144:159]
    s_nop 7
    s_nop 4
    v_max3_f32 v211, v128, v129, v209
    v_max3_f32 v211, v130, v131, v211
    v_max3_f32 v211, v132, v133, v211
    v_max3_f32 v211, v134, v135, v211
    v_max3_f32 v211, v136, v137, v211
    v_max3_f32 v211, v138, v139, v211
    v_max3_f32 v211, v140, v141, v211
    v_max3_f32 v211, v142, v143, v211
    v_max3_f32 v211, v144, v145, v211
    v_max3_f32 v211, v146, v147, v211
    v_max3_f32 v211, v148, v149, v211
    v_max3_f32 v211, v150, v151, v211
    v_max3_f32 v211, v152, v153, v211
    v_max3_f32 v211, v154, v155, v211
    v_max3_f32 v211, v156, v157, v211
    v_max3_f32 v211, v158, v159, v211
    v_mov_b32 v212, v211
    s_nop 1
    v_permlane32_swap_b32 v211, v212
    s_nop 1
    v_max_f32 v211, v211, v212
    v_sub_f32 v213, v209, v211
    v_exp_f32 v213, v213
    v_mov_b32 v209, v211
    v_sub_f32 v128, v128, v211
    v_exp_f32 v128, v128
    v_sub_f32 v129, v129, v211
    v_exp_f32 v129, v129
    v_sub_f32 v130, v130, v211
    v_exp_f32 v130, v130
    v_sub_f32 v131, v131, v211
    v_exp_f32 v131, v131
    v_sub_f32 v132, v132, v211
    v_exp_f32 v132, v132
    v_sub_f32 v133, v133, v211
    v_exp_f32 v133, v133
    v_sub_f32 v134, v134, v211
    v_exp_f32 v134, v134
    v_sub_f32 v135, v135, v211
    v_exp_f32 v135, v135
    v_sub_f32 v136, v136, v211
    v_exp_f32 v136, v136
    v_sub_f32 v137, v137, v211
    v_exp_f32 v137, v137
    v_sub_f32 v138, v138, v211
    v_exp_f32 v138, v138
    v_sub_f32 v139, v139, v211
    v_exp_f32 v139, v139
    v_sub_f32 v140, v140, v211
    v_exp_f32 v140, v140
    v_sub_f32 v141, v141, v211
    v_exp_f32 v141, v141
    v_sub_f32 v142, v142, v211
    v_exp_f32 v142, v142
    v_sub_f32 v143, v143, v211
    v_exp_f32 v143, v143
    v_sub_f32 v144, v144, v211
    v_exp_f32 v144, v144
    v_sub_f32 v145, v145, v211
    v_exp_f32 v145, v145
    v_sub_f32 v146, v146, v211
    v_exp_f32 v146, v146
    v_sub_f32 v147, v147, v211
    v_exp_f32 v147, v147
    v_sub_f32 v148, v148, v211
    v_exp_f32 v148, v148
    v_sub_f32 v149, v149, v211
    v_exp_f32 v149, v149
    v_sub_f32 v150, v150, v211
    v_exp_f32 v150, v150
    v_sub_f32 v151, v151, v211
    v_exp_f32 v151, v151
    v_sub_f32 v152, v152, v211
    v_exp_f32 v152, v152
    v_sub_f32 v153, v153, v211
    v_exp_f32 v153, v153
    v_sub_f32 v154, v154, v211
    v_exp_f32 v154, v154
    v_sub_f32 v155, v155, v211
    v_exp_f32 v155, v155
    v_sub_f32 v156, v156, v211
    v_exp_f32 v156, v156
    v_sub_f32 v157, v157, v211
    v_exp_f32 v157, v157
    v_sub_f32 v158, v158, v211
    v_exp_f32 v158, v158
    v_sub_f32 v159, v159, v211
    v_exp_f32 v159, v159
    v_mul_f32 v210, v210, v213
    v_mul_f32 v64, v64, v213
    v_mul_f32 v65, v65, v213
    v_mul_f32 v66, v66, v213
    v_mul_f32 v67, v67, v213
    v_mul_f32 v68, v68, v213
    v_mul_f32 v69, v69, v213
    v_mul_f32 v70, v70, v213
    v_mul_f32 v71, v71, v213
    v_mul_f32 v72, v72, v213
    v_mul_f32 v73, v73, v213
    v_mul_f32 v74, v74, v213
    v_mul_f32 v75, v75, v213
    v_mul_f32 v76, v76, v213
    v_mul_f32 v77, v77, v213
    v_mul_f32 v78, v78, v213
    v_mul_f32 v79, v79, v213
    v_mul_f32 v80, v80, v213
    v_mul_f32 v81, v81, v213
    v_mul_f32 v82, v82, v213
    v_mul_f32 v83, v83, v213
    v_mul_f32 v84, v84, v213
    v_mul_f32 v85, v85, v213
    v_mul_f32 v86, v86, v213
    v_mul_f32 v87, v87, v213
    v_mul_f32 v88, v88, v213
    v_mul_f32 v89, v89, v213
    v_mul_f32 v90, v90, v213
    v_mul_f32 v91, v91, v213
    v_mul_f32 v92, v92, v213
    v_mul_f32 v93, v93, v213
    v_mul_f32 v94, v94, v213
    v_mul_f32 v95, v95, v213
    v_mul_f32 v96, v96, v213
    v_mul_f32 v97, v97, v213
    v_mul_f32 v98, v98, v213
    v_mul_f32 v99, v99, v213
    v_mul_f32 v100, v100, v213
    v_mul_f32 v101, v101, v213
    v_mul_f32 v102, v102, v213
    v_mul_f32 v103, v103, v213
    v_mul_f32 v104, v104, v213
    v_mul_f32 v105, v105, v213
    v_mul_f32 v106, v106, v213
    v_mul_f32 v107, v107, v213
    v_mul_f32 v108, v108, v213
    v_mul_f32 v109, v109, v213
    v_mul_f32 v110, v110, v213
    v_mul_f32 v111, v111, v213
    v_mul_f32 v112, v112, v213
    v_mul_f32 v113, v113, v213
    v_mul_f32 v114, v114, v213
    v_mul_f32 v115, v115, v213
    v_mul_f32 v116, v116, v213
    v_mul_f32 v117, v117, v213
    v_mul_f32 v118, v118, v213
    v_mul_f32 v119, v119, v213
    v_mul_f32 v120, v120, v213
    v_mul_f32 v121, v121, v213
    v_mul_f32 v122, v122, v213
    v_mul_f32 v123, v123, v213
    v_mul_f32 v124, v124, v213
    v_mul_f32 v125, v125, v213
    v_mul_f32 v126, v126, v213
    v_mul_f32 v127, v127, v213
    v_add_f32 v210, v210, v128
    v_add_f32 v210, v210, v129
    v_add_f32 v210, v210, v130
    v_add_f32 v210, v210, v131
    v_add_f32 v210, v210, v132
    v_add_f32 v210, v210, v133
    v_add_f32 v210, v210, v134
    v_add_f32 v210, v210, v135
    v_add_f32 v210, v210, v136
    v_add_f32 v210, v210, v137
    v_add_f32 v210, v210, v138
    v_add_f32 v210, v210, v139
    v_add_f32 v210, v210, v140
    v_add_f32 v210, v210, v141
    v_add_f32 v210, v210, v142
    v_add_f32 v210, v210, v143
    v_add_f32 v210, v210, v144
    v_add_f32 v210, v210, v145
    v_add_f32 v210, v210, v146
    v_add_f32 v210, v210, v147
    v_add_f32 v210, v210, v148
    v_add_f32 v210, v210, v149
    v_add_f32 v210, v210, v150
    v_add_f32 v210, v210, v151
    v_add_f32 v210, v210, v152
    v_add_f32 v210, v210, v153
    v_add_f32 v210, v210, v154
    v_add_f32 v210, v210, v155
    v_add_f32 v210, v210, v156
    v_add_f32 v210, v210, v157
    v_add_f32 v210, v210, v158
    v_add_f32 v210, v210, v159
    v_cvt_pk_bf16_f32 v160, v128, v129
    v_cvt_pk_bf16_f32 v161, v130, v131
    v_cvt_pk_bf16_f32 v162, v132, v133
    v_cvt_pk_bf16_f32 v163, v134, v135
    v_cvt_pk_bf16_f32 v164, v136, v137
    v_cvt_pk_bf16_f32 v165, v138, v139
    v_cvt_pk_bf16_f32 v166, v140, v141
    v_cvt_pk_bf16_f32 v167, v142, v143
    v_cvt_pk_bf16_f32 v168, v144, v145
    v_cvt_pk_bf16_f32 v169, v146, v147
    v_cvt_pk_bf16_f32 v170, v148, v149
    v_cvt_pk_bf16_f32 v171, v150, v151
    v_cvt_pk_bf16_f32 v172, v152, v153
    v_cvt_pk_bf16_f32 v173, v154, v155
    v_cvt_pk_bf16_f32 v174, v156, v157
    v_cvt_pk_bf16_f32 v175, v158, v159
    s_waitcnt vmcnt(8)
    s_barrier
    s_add_u32 m0, s44, 32768
    s_add_u32 s41, s2, 7
    s_and_b32 s41, s41, 7
    s_lshl_b32 s41, s41, 14
    s_add_u32 s40, s41, s44
    buffer_load_dwordx4 v216, s[24:27], s40 offen offset:0 lds
    s_add_u32 s41, s2, 7
    s_and_b32 s41, s41, 7
    s_lshl_b32 s41, s41, 14
    s_add_u32 s40, s41, s44
    buffer_load_dwordx4 v217, s[24:27], s40 offen offset:1024 lds
    s_add_u32 s41, s2, 7
    s_and_b32 s41, s41, 7
    s_lshl_b32 s41, s41, 14
    s_add_u32 s40, s41, s44
    buffer_load_dwordx4 v218, s[24:27], s40 offen offset:2048 lds
    s_add_u32 s41, s2, 7
    s_and_b32 s41, s41, 7
    s_lshl_b32 s41, s41, 14
    s_add_u32 s40, s41, s44
    buffer_load_dwordx4 v219, s[24:27], s40 offen offset:3072 lds
    ds_read_b64_tr_b16 v[176:176+1], v200 offset:49152
    ds_read_b64_tr_b16 v[178:178+1], v200 offset:51200
    ds_read_b64_tr_b16 v[180:180+1], v201 offset:49152
    ds_read_b64_tr_b16 v[182:182+1], v201 offset:51200
    ds_read_b64_tr_b16 v[184:184+1], v202 offset:49152
    ds_read_b64_tr_b16 v[186:186+1], v202 offset:51200
    ds_read_b64_tr_b16 v[188:188+1], v203 offset:49152
    ds_read_b64_tr_b16 v[190:190+1], v203 offset:51200
    s_waitcnt lgkmcnt(6)
    v_mfma_f32_32x32x16_bf16 v[64:79], v[176:179], v[160:163], v[64:79]
    ds_read_b64_tr_b16 v[176:176+1], v200 offset:53248
    ds_read_b64_tr_b16 v[178:178+1], v200 offset:55296
    s_waitcnt lgkmcnt(6)
    v_mfma_f32_32x32x16_bf16 v[80:95], v[180:183], v[160:163], v[80:95]
    ds_read_b64_tr_b16 v[180:180+1], v201 offset:53248
    ds_read_b64_tr_b16 v[182:182+1], v201 offset:55296
    s_waitcnt lgkmcnt(6)
    v_mfma_f32_32x32x16_bf16 v[96:111], v[184:187], v[160:163], v[96:111]
    ds_read_b64_tr_b16 v[184:184+1], v202 offset:53248
    ds_read_b64_tr_b16 v[186:186+1], v202 offset:55296
    s_waitcnt lgkmcnt(6)
    v_mfma_f32_32x32x16_bf16 v[112:127], v[188:191], v[160:163], v[112:127]
    ds_read_b64_tr_b16 v[188:188+1], v203 offset:53248
    ds_read_b64_tr_b16 v[190:190+1], v203 offset:55296
    s_waitcnt lgkmcnt(6)
    v_mfma_f32_32x32x16_bf16 v[64:79], v[176:179], v[164:167], v[64:79]
    ds_read_b64_tr_b16 v[176:176+1], v200 offset:57344
    ds_read_b64_tr_b16 v[178:178+1], v200 offset:59392
    s_waitcnt lgkmcnt(6)
    v_mfma_f32_32x32x16_bf16 v[80:95], v[180:183], v[164:167], v[80:95]
    ds_read_b64_tr_b16 v[180:180+1], v201 offset:57344
    ds_read_b64_tr_b16 v[182:182+1], v201 offset:59392
    s_waitcnt lgkmcnt(6)
    v_mfma_f32_32x32x16_bf16 v[96:111], v[184:187], v[164:167], v[96:111]
    ds_read_b64_tr_b16 v[184:184+1], v202 offset:57344
    ds_read_b64_tr_b16 v[186:186+1], v202 offset:59392
    s_waitcnt lgkmcnt(6)
    v_mfma_f32_32x32x16_bf16 v[112:127], v[188:191], v[164:167], v[112:127]
    ds_read_b64_tr_b16 v[188:188+1], v203 offset:57344
    ds_read_b64_tr_b16 v[190:190+1], v203 offset:59392
    s_waitcnt lgkmcnt(6)
    v_mfma_f32_32x32x16_bf16 v[64:79], v[176:179], v[168:171], v[64:79]
    ds_read_b64_tr_b16 v[176:176+1], v200 offset:61440
    ds_read_b64_tr_b16 v[178:178+1], v200 offset:63488
    s_waitcnt lgkmcnt(6)
    v_mfma_f32_32x32x16_bf16 v[80:95], v[180:183], v[168:171], v[80:95]
    ds_read_b64_tr_b16 v[180:180+1], v201 offset:61440
    ds_read_b64_tr_b16 v[182:182+1], v201 offset:63488
    s_waitcnt lgkmcnt(6)
    v_mfma_f32_32x32x16_bf16 v[96:111], v[184:187], v[168:171], v[96:111]
    ds_read_b64_tr_b16 v[184:184+1], v202 offset:61440
    ds_read_b64_tr_b16 v[186:186+1], v202 offset:63488
    s_waitcnt lgkmcnt(6)
    v_mfma_f32_32x32x16_bf16 v[112:127], v[188:191], v[168:171], v[112:127]
    ds_read_b64_tr_b16 v[188:188+1], v203 offset:61440
    ds_read_b64_tr_b16 v[190:190+1], v203 offset:63488
    s_waitcnt lgkmcnt(6)
    v_mfma_f32_32x32x16_bf16 v[64:79], v[176:179], v[172:175], v[64:79]
    s_waitcnt lgkmcnt(4)
    v_mfma_f32_32x32x16_bf16 v[80:95], v[180:183], v[172:175], v[80:95]
    s_waitcnt lgkmcnt(2)
    v_mfma_f32_32x32x16_bf16 v[96:111], v[184:187], v[172:175], v[96:111]
    s_waitcnt lgkmcnt(0)
    v_mfma_f32_32x32x16_bf16 v[112:127], v[188:191], v[172:175], v[112:127]
    s_waitcnt vmcnt(8)
    s_barrier
    s_add_u32 m0, s44, 49152
    s_add_u32 s41, s2, 7
    s_and_b32 s41, s41, 7
    s_lshl_b32 s41, s41, 14
    s_add_u32 s40, s41, s44
    buffer_load_dwordx4 v220, s[28:31], s40 offen offset:0 lds
    s_add_u32 s41, s2, 7
    s_and_b32 s41, s41, 7
    s_lshl_b32 s41, s41, 14
    s_add_u32 s40, s41, s44
    buffer_load_dwordx4 v220, s[28:31], s40 offen offset:1024 lds
    s_add_u32 s41, s2, 7
    s_and_b32 s41, s41, 7
    s_lshl_b32 s41, s41, 14
    s_add_u32 s40, s41, s44
    buffer_load_dwordx4 v220, s[28:31], s40 offen offset:2048 lds
    s_add_u32 s41, s2, 7
    s_and_b32 s41, s41, 7
    s_lshl_b32 s41, s41, 14
    s_add_u32 s40, s41, s44
    buffer_load_dwordx4 v220, s[28:31], s40 offen offset:3072 lds
    ds_read_b128 v[176:176+3], v192 offset:0
    ds_read_b128 v[180:180+3], v193 offset:0
    ds_read_b128 v[184:184+3], v194 offset:0
    ds_read_b128 v[188:188+3], v195 offset:0
    s_waitcnt lgkmcnt(3)
    v_mfma_f32_32x32x16_bf16 v[128:143], v[176:179], v[32:35], 0
    ds_read_b128 v[176:176+3], v196 offset:0
    s_waitcnt lgkmcnt(3)
    v_mfma_f32_32x32x16_bf16 v[128:143], v[180:183], v[36:39], v[128:143]
    ds_read_b128 v[180:180+3], v197 offset:0
    s_waitcnt lgkmcnt(3)
    v_mfma_f32_32x32x16_bf16 v[128:143], v[184:187], v[40:43], v[128:143]
    ds_read_b128 v[184:184+3], v198 offset:0
    s_waitcnt lgkmcnt(3)
    v_mfma_f32_32x32x16_bf16 v[128:143], v[188:191], v[44:47], v[128:143]
    ds_read_b128 v[188:188+3], v199 offset:0
    s_waitcnt lgkmcnt(3)
    v_mfma_f32_32x32x16_bf16 v[128:143], v[176:179], v[48:51], v[128:143]
    ds_read_b128 v[176:176+3], v192 offset:8192
    s_waitcnt lgkmcnt(3)
    v_mfma_f32_32x32x16_bf16 v[128:143], v[180:183], v[52:55], v[128:143]
    ds_read_b128 v[180:180+3], v193 offset:8192
    s_waitcnt lgkmcnt(3)
    v_mfma_f32_32x32x16_bf16 v[128:143], v[184:187], v[56:59], v[128:143]
    ds_read_b128 v[184:184+3], v194 offset:8192
    s_waitcnt lgkmcnt(3)
    v_mfma_f32_32x32x16_bf16 v[128:143], v[188:191], v[60:63], v[128:143]
    ds_read_b128 v[188:188+3], v195 offset:8192
    s_waitcnt lgkmcnt(3)
    v_mfma_f32_32x32x16_bf16 v[144:159], v[176:179], v[32:35], 0
    ds_read_b128 v[176:176+3], v196 offset:8192
    s_waitcnt lgkmcnt(3)
    v_mfma_f32_32x32x16_bf16 v[144:159], v[180:183], v[36:39], v[144:159]
    ds_read_b128 v[180:180+3], v197 offset:8192
    s_waitcnt lgkmcnt(3)
    v_mfma_f32_32x32x16_bf16 v[144:159], v[184:187], v[40:43], v[144:159]
    ds_read_b128 v[184:184+3], v198 offset:8192
    s_waitcnt lgkmcnt(3)
    v_mfma_f32_32x32x16_bf16 v[144:159], v[188:191], v[44:47], v[144:159]
    ds_read_b128 v[188:188+3], v199 offset:8192
    s_waitcnt lgkmcnt(3)
    v_mfma_f32_32x32x16_bf16 v[144:159], v[176:179], v[48:51], v[144:159]
    s_waitcnt lgkmcnt(2)
    v_mfma_f32_32x32x16_bf16 v[144:159], v[180:183], v[52:55], v[144:159]
    s_waitcnt lgkmcnt(1)
    v_mfma_f32_32x32x16_bf16 v[144:159], v[184:187], v[56:59], v[144:159]
    s_waitcnt lgkmcnt(0)
    v_mfma_f32_32x32x16_bf16 v[144:159], v[188:191], v[60:63], v[144:159]
    s_nop 7
    s_nop 4
    v_max3_f32 v211, v128, v129, v209
    v_max3_f32 v211, v130, v131, v211
    v_max3_f32 v211, v132, v133, v211
    v_max3_f32 v211, v134, v135, v211
    v_max3_f32 v211, v136, v137, v211
    v_max3_f32 v211, v138, v139, v211
    v_max3_f32 v211, v140, v141, v211
    v_max3_f32 v211, v142, v143, v211
    v_max3_f32 v211, v144, v145, v211
    v_max3_f32 v211, v146, v147, v211
    v_max3_f32 v211, v148, v149, v211
    v_max3_f32 v211, v150, v151, v211
    v_max3_f32 v211, v152, v153, v211
    v_max3_f32 v211, v154, v155, v211
    v_max3_f32 v211, v156, v157, v211
    v_max3_f32 v211, v158, v159, v211
    v_mov_b32 v212, v211
    s_nop 1
    v_permlane32_swap_b32 v211, v212
    s_nop 1
    v_max_f32 v211, v211, v212
    v_sub_f32 v213, v209, v211
    v_exp_f32 v213, v213
    v_mov_b32 v209, v211
    v_sub_f32 v128, v128, v211
    v_exp_f32 v128, v128
    v_sub_f32 v129, v129, v211
    v_exp_f32 v129, v129
    v_sub_f32 v130, v130, v211
    v_exp_f32 v130, v130
    v_sub_f32 v131, v131, v211
    v_exp_f32 v131, v131
    v_sub_f32 v132, v132, v211
    v_exp_f32 v132, v132
    v_sub_f32 v133, v133, v211
    v_exp_f32 v133, v133
    v_sub_f32 v134, v134, v211
    v_exp_f32 v134, v134
    v_sub_f32 v135, v135, v211
    v_exp_f32 v135, v135
    v_sub_f32 v136, v136, v211
    v_exp_f32 v136, v136
    v_sub_f32 v137, v137, v211
    v_exp_f32 v137, v137
    v_sub_f32 v138, v138, v211
    v_exp_f32 v138, v138
    v_sub_f32 v139, v139, v211
    v_exp_f32 v139, v139
    v_sub_f32 v140, v140, v211
    v_exp_f32 v140, v140
    v_sub_f32 v141, v141, v211
    v_exp_f32 v141, v141
    v_sub_f32 v142, v142, v211
    v_exp_f32 v142, v142
    v_sub_f32 v143, v143, v211
    v_exp_f32 v143, v143
    v_sub_f32 v144, v144, v211
    v_exp_f32 v144, v144
    v_sub_f32 v145, v145, v211
    v_exp_f32 v145, v145
    v_sub_f32 v146, v146, v211
    v_exp_f32 v146, v146
    v_sub_f32 v147, v147, v211
    v_exp_f32 v147, v147
    v_sub_f32 v148, v148, v211
    v_exp_f32 v148, v148
    v_sub_f32 v149, v149, v211
    v_exp_f32 v149, v149
    v_sub_f32 v150, v150, v211
    v_exp_f32 v150, v150
    v_sub_f32 v151, v151, v211
    v_exp_f32 v151, v151
    v_sub_f32 v152, v152, v211
    v_exp_f32 v152, v152
    v_sub_f32 v153, v153, v211
    v_exp_f32 v153, v153
    v_sub_f32 v154, v154, v211
    v_exp_f32 v154, v154
    v_sub_f32 v155, v155, v211
    v_exp_f32 v155, v155
    v_sub_f32 v156, v156, v211
    v_exp_f32 v156, v156
    v_sub_f32 v157, v157, v211
    v_exp_f32 v157, v157
    v_sub_f32 v158, v158, v211
    v_exp_f32 v158, v158
    v_sub_f32 v159, v159, v211
    v_exp_f32 v159, v159
    v_mul_f32 v210, v210, v213
    v_mul_f32 v64, v64, v213
    v_mul_f32 v65, v65, v213
    v_mul_f32 v66, v66, v213
    v_mul_f32 v67, v67, v213
    v_mul_f32 v68, v68, v213
    v_mul_f32 v69, v69, v213
    v_mul_f32 v70, v70, v213
    v_mul_f32 v71, v71, v213
    v_mul_f32 v72, v72, v213
    v_mul_f32 v73, v73, v213
    v_mul_f32 v74, v74, v213
    v_mul_f32 v75, v75, v213
    v_mul_f32 v76, v76, v213
    v_mul_f32 v77, v77, v213
    v_mul_f32 v78, v78, v213
    v_mul_f32 v79, v79, v213
    v_mul_f32 v80, v80, v213
    v_mul_f32 v81, v81, v213
    v_mul_f32 v82, v82, v213
    v_mul_f32 v83, v83, v213
    v_mul_f32 v84, v84, v213
    v_mul_f32 v85, v85, v213
    v_mul_f32 v86, v86, v213
    v_mul_f32 v87, v87, v213
    v_mul_f32 v88, v88, v213
    v_mul_f32 v89, v89, v213
    v_mul_f32 v90, v90, v213
    v_mul_f32 v91, v91, v213
    v_mul_f32 v92, v92, v213
    v_mul_f32 v93, v93, v213
    v_mul_f32 v94, v94, v213
    v_mul_f32 v95, v95, v213
    v_mul_f32 v96, v96, v213
    v_mul_f32 v97, v97, v213
    v_mul_f32 v98, v98, v213
    v_mul_f32 v99, v99, v213
    v_mul_f32 v100, v100, v213
    v_mul_f32 v101, v101, v213
    v_mul_f32 v102, v102, v213
    v_mul_f32 v103, v103, v213
    v_mul_f32 v104, v104, v213
    v_mul_f32 v105, v105, v213
    v_mul_f32 v106, v106, v213
    v_mul_f32 v107, v107, v213
    v_mul_f32 v108, v108, v213
    v_mul_f32 v109, v109, v213
    v_mul_f32 v110, v110, v213
    v_mul_f32 v111, v111, v213
    v_mul_f32 v112, v112, v213
    v_mul_f32 v113, v113, v213
    v_mul_f32 v114, v114, v213
    v_mul_f32 v115, v115, v213
    v_mul_f32 v116, v116, v213
    v_mul_f32 v117, v117, v213
    v_mul_f32 v118, v118, v213
    v_mul_f32 v119, v119, v213
    v_mul_f32 v120, v120, v213
    v_mul_f32 v121, v121, v213
    v_mul_f32 v122, v122, v213
    v_mul_f32 v123, v123, v213
    v_mul_f32 v124, v124, v213
    v_mul_f32 v125, v125, v213
    v_mul_f32 v126, v126, v213
    v_mul_f32 v127, v127, v213
    v_add_f32 v210, v210, v128
    v_add_f32 v210, v210, v129
    v_add_f32 v210, v210, v130
    v_add_f32 v210, v210, v131
    v_add_f32 v210, v210, v132
    v_add_f32 v210, v210, v133
    v_add_f32 v210, v210, v134
    v_add_f32 v210, v210, v135
    v_add_f32 v210, v210, v136
    v_add_f32 v210, v210, v137
    v_add_f32 v210, v210, v138
    v_add_f32 v210, v210, v139
    v_add_f32 v210, v210, v140
    v_add_f32 v210, v210, v141
    v_add_f32 v210, v210, v142
    v_add_f32 v210, v210, v143
    v_add_f32 v210, v210, v144
    v_add_f32 v210, v210, v145
    v_add_f32 v210, v210, v146
    v_add_f32 v210, v210, v147
    v_add_f32 v210, v210, v148
    v_add_f32 v210, v210, v149
    v_add_f32 v210, v210, v150
    v_add_f32 v210, v210, v151
    v_add_f32 v210, v210, v152
    v_add_f32 v210, v210, v153
    v_add_f32 v210, v210, v154
    v_add_f32 v210, v210, v155
    v_add_f32 v210, v210, v156
    v_add_f32 v210, v210, v157
    v_add_f32 v210, v210, v158
    v_add_f32 v210, v210, v159
    v_cvt_pk_bf16_f32 v160, v128, v129
    v_cvt_pk_bf16_f32 v161, v130, v131
    v_cvt_pk_bf16_f32 v162, v132, v133
    v_cvt_pk_bf16_f32 v163, v134, v135
    v_cvt_pk_bf16_f32 v164, v136, v137
    v_cvt_pk_bf16_f32 v165, v138, v139
    v_cvt_pk_bf16_f32 v166, v140, v141
    v_cvt_pk_bf16_f32 v167, v142, v143
    v_cvt_pk_bf16_f32 v168, v144, v145
    v_cvt_pk_bf16_f32 v169, v146, v147
    v_cvt_pk_bf16_f32 v170, v148, v149
    v_cvt_pk_bf16_f32 v171, v150, v151
    v_cvt_pk_bf16_f32 v172, v152, v153
    v_cvt_pk_bf16_f32 v173, v154, v155
    v_cvt_pk_bf16_f32 v174, v156, v157
    v_cvt_pk_bf16_f32 v175, v158, v159
    s_waitcnt vmcnt(8)
    s_barrier
    ds_read_b64_tr_b16 v[176:176+1], v200 offset:16384
    ds_read_b64_tr_b16 v[178:178+1], v200 offset:18432
    ds_read_b64_tr_b16 v[180:180+1], v201 offset:16384
    ds_read_b64_tr_b16 v[182:182+1], v201 offset:18432
    ds_read_b64_tr_b16 v[184:184+1], v202 offset:16384
    ds_read_b64_tr_b16 v[186:186+1], v202 offset:18432
    ds_read_b64_tr_b16 v[188:188+1], v203 offset:16384
    ds_read_b64_tr_b16 v[190:190+1], v203 offset:18432
    s_waitcnt lgkmcnt(6)
    v_mfma_f32_32x32x16_bf16 v[64:79], v[176:179], v[160:163], v[64:79]
    ds_read_b64_tr_b16 v[176:176+1], v200 offset:20480
    ds_read_b64_tr_b16 v[178:178+1], v200 offset:22528
    s_waitcnt lgkmcnt(6)
    v_mfma_f32_32x32x16_bf16 v[80:95], v[180:183], v[160:163], v[80:95]
    ds_read_b64_tr_b16 v[180:180+1], v201 offset:20480
    ds_read_b64_tr_b16 v[182:182+1], v201 offset:22528
    s_waitcnt lgkmcnt(6)
    v_mfma_f32_32x32x16_bf16 v[96:111], v[184:187], v[160:163], v[96:111]
    ds_read_b64_tr_b16 v[184:184+1], v202 offset:20480
    ds_read_b64_tr_b16 v[186:186+1], v202 offset:22528
    s_waitcnt lgkmcnt(6)
    v_mfma_f32_32x32x16_bf16 v[112:127], v[188:191], v[160:163], v[112:127]
    ds_read_b64_tr_b16 v[188:188+1], v203 offset:20480
    ds_read_b64_tr_b16 v[190:190+1], v203 offset:22528
    s_waitcnt lgkmcnt(6)
    v_mfma_f32_32x32x16_bf16 v[64:79], v[176:179], v[164:167], v[64:79]
    ds_read_b64_tr_b16 v[176:176+1], v200 offset:24576
    ds_read_b64_tr_b16 v[178:178+1], v200 offset:26624
    s_waitcnt lgkmcnt(6)
    v_mfma_f32_32x32x16_bf16 v[80:95], v[180:183], v[164:167], v[80:95]
    ds_read_b64_tr_b16 v[180:180+1], v201 offset:24576
    ds_read_b64_tr_b16 v[182:182+1], v201 offset:26624
    s_waitcnt lgkmcnt(6)
    v_mfma_f32_32x32x16_bf16 v[96:111], v[184:187], v[164:167], v[96:111]
    ds_read_b64_tr_b16 v[184:184+1], v202 offset:24576
    ds_read_b64_tr_b16 v[186:186+1], v202 offset:26624
    s_waitcnt lgkmcnt(6)
    v_mfma_f32_32x32x16_bf16 v[112:127], v[188:191], v[164:167], v[112:127]
    ds_read_b64_tr_b16 v[188:188+1], v203 offset:24576
    ds_read_b64_tr_b16 v[190:190+1], v203 offset:26624
    s_waitcnt lgkmcnt(6)
    v_mfma_f32_32x32x16_bf16 v[64:79], v[176:179], v[168:171], v[64:79]
    ds_read_b64_tr_b16 v[176:176+1], v200 offset:28672
    ds_read_b64_tr_b16 v[178:178+1], v200 offset:30720
    s_waitcnt lgkmcnt(6)
    v_mfma_f32_32x32x16_bf16 v[80:95], v[180:183], v[168:171], v[80:95]
    ds_read_b64_tr_b16 v[180:180+1], v201 offset:28672
    ds_read_b64_tr_b16 v[182:182+1], v201 offset:30720
    s_waitcnt lgkmcnt(6)
    v_mfma_f32_32x32x16_bf16 v[96:111], v[184:187], v[168:171], v[96:111]
    ds_read_b64_tr_b16 v[184:184+1], v202 offset:28672
    ds_read_b64_tr_b16 v[186:186+1], v202 offset:30720
    s_waitcnt lgkmcnt(6)
    v_mfma_f32_32x32x16_bf16 v[112:127], v[188:191], v[168:171], v[112:127]
    ds_read_b64_tr_b16 v[188:188+1], v203 offset:28672
    ds_read_b64_tr_b16 v[190:190+1], v203 offset:30720
    s_waitcnt lgkmcnt(6)
    v_mfma_f32_32x32x16_bf16 v[64:79], v[176:179], v[172:175], v[64:79]
    s_waitcnt lgkmcnt(4)
    v_mfma_f32_32x32x16_bf16 v[80:95], v[180:183], v[172:175], v[80:95]
    s_waitcnt lgkmcnt(2)
    v_mfma_f32_32x32x16_bf16 v[96:111], v[184:187], v[172:175], v[96:111]
    s_waitcnt lgkmcnt(0)
    v_mfma_f32_32x32x16_bf16 v[112:127], v[188:191], v[172:175], v[112:127]
    s_waitcnt vmcnt(4)
    s_barrier
    ds_read_b128 v[176:176+3], v192 offset:32768
    ds_read_b128 v[180:180+3], v193 offset:32768
    ds_read_b128 v[184:184+3], v194 offset:32768
    ds_read_b128 v[188:188+3], v195 offset:32768
    s_waitcnt lgkmcnt(3)
    v_mfma_f32_32x32x16_bf16 v[128:143], v[176:179], v[32:35], 0
    ds_read_b128 v[176:176+3], v196 offset:32768
    s_waitcnt lgkmcnt(3)
    v_mfma_f32_32x32x16_bf16 v[128:143], v[180:183], v[36:39], v[128:143]
    ds_read_b128 v[180:180+3], v197 offset:32768
    s_waitcnt lgkmcnt(3)
    v_mfma_f32_32x32x16_bf16 v[128:143], v[184:187], v[40:43], v[128:143]
    ds_read_b128 v[184:184+3], v198 offset:32768
    s_waitcnt lgkmcnt(3)
    v_mfma_f32_32x32x16_bf16 v[128:143], v[188:191], v[44:47], v[128:143]
    ds_read_b128 v[188:188+3], v199 offset:32768
    s_waitcnt lgkmcnt(3)
    v_mfma_f32_32x32x16_bf16 v[128:143], v[176:179], v[48:51], v[128:143]
    ds_read_b128 v[176:176+3], v192 offset:40960
    s_waitcnt lgkmcnt(3)
    v_mfma_f32_32x32x16_bf16 v[128:143], v[180:183], v[52:55], v[128:143]
    ds_read_b128 v[180:180+3], v193 offset:40960
    s_waitcnt lgkmcnt(3)
    v_mfma_f32_32x32x16_bf16 v[128:143], v[184:187], v[56:59], v[128:143]
    ds_read_b128 v[184:184+3], v194 offset:40960
    s_waitcnt lgkmcnt(3)
    v_mfma_f32_32x32x16_bf16 v[128:143], v[188:191], v[60:63], v[128:143]
    ds_read_b128 v[188:188+3], v195 offset:40960
    s_waitcnt lgkmcnt(3)
    v_mfma_f32_32x32x16_bf16 v[144:159], v[176:179], v[32:35], 0
    ds_read_b128 v[176:176+3], v196 offset:40960
    s_waitcnt lgkmcnt(3)
    v_mfma_f32_32x32x16_bf16 v[144:159], v[180:183], v[36:39], v[144:159]
    ds_read_b128 v[180:180+3], v197 offset:40960
    s_waitcnt lgkmcnt(3)
    v_mfma_f32_32x32x16_bf16 v[144:159], v[184:187], v[40:43], v[144:159]
    ds_read_b128 v[184:184+3], v198 offset:40960
    s_waitcnt lgkmcnt(3)
    v_mfma_f32_32x32x16_bf16 v[144:159], v[188:191], v[44:47], v[144:159]
    ds_read_b128 v[188:188+3], v199 offset:40960
    s_waitcnt lgkmcnt(3)
    v_mfma_f32_32x32x16_bf16 v[144:159], v[176:179], v[48:51], v[144:159]
    s_waitcnt lgkmcnt(2)
    v_mfma_f32_32x32x16_bf16 v[144:159], v[180:183], v[52:55], v[144:159]
    s_waitcnt lgkmcnt(1)
    v_mfma_f32_32x32x16_bf16 v[144:159], v[184:187], v[56:59], v[144:159]
    s_waitcnt lgkmcnt(0)
    v_mfma_f32_32x32x16_bf16 v[144:159], v[188:191], v[60:63], v[144:159]
    s_nop 7
    s_nop 4
    v_max3_f32 v211, v128, v129, v209
    v_max3_f32 v211, v130, v131, v211
    v_max3_f32 v211, v132, v133, v211
    v_max3_f32 v211, v134, v135, v211
    v_max3_f32 v211, v136, v137, v211
    v_max3_f32 v211, v138, v139, v211
    v_max3_f32 v211, v140, v141, v211
    v_max3_f32 v211, v142, v143, v211
    v_max3_f32 v211, v144, v145, v211
    v_max3_f32 v211, v146, v147, v211
    v_max3_f32 v211, v148, v149, v211
    v_max3_f32 v211, v150, v151, v211
    v_max3_f32 v211, v152, v153, v211
    v_max3_f32 v211, v154, v155, v211
    v_max3_f32 v211, v156, v157, v211
    v_max3_f32 v211, v158, v159, v211
    v_mov_b32 v212, v211
    s_nop 1
    v_permlane32_swap_b32 v211, v212
    s_nop 1
    v_max_f32 v211, v211, v212
    v_sub_f32 v213, v209, v211
    v_exp_f32 v213, v213
    v_mov_b32 v209, v211
    v_sub_f32 v128, v128, v211
    v_exp_f32 v128, v128
    v_sub_f32 v129, v129, v211
    v_exp_f32 v129, v129
    v_sub_f32 v130, v130, v211
    v_exp_f32 v130, v130
    v_sub_f32 v131, v131, v211
    v_exp_f32 v131, v131
    v_sub_f32 v132, v132, v211
    v_exp_f32 v132, v132
    v_sub_f32 v133, v133, v211
    v_exp_f32 v133, v133
    v_sub_f32 v134, v134, v211
    v_exp_f32 v134, v134
    v_sub_f32 v135, v135, v211
    v_exp_f32 v135, v135
    v_sub_f32 v136, v136, v211
    v_exp_f32 v136, v136
    v_sub_f32 v137, v137, v211
    v_exp_f32 v137, v137
    v_sub_f32 v138, v138, v211
    v_exp_f32 v138, v138
    v_sub_f32 v139, v139, v211
    v_exp_f32 v139, v139
    v_sub_f32 v140, v140, v211
    v_exp_f32 v140, v140
    v_sub_f32 v141, v141, v211
    v_exp_f32 v141, v141
    v_sub_f32 v142, v142, v211
    v_exp_f32 v142, v142
    v_sub_f32 v143, v143, v211
    v_exp_f32 v143, v143
    v_sub_f32 v144, v144, v211
    v_exp_f32 v144, v144
    v_sub_f32 v145, v145, v211
    v_exp_f32 v145, v145
    v_sub_f32 v146, v146, v211
    v_exp_f32 v146, v146
    v_sub_f32 v147, v147, v211
    v_exp_f32 v147, v147
    v_sub_f32 v148, v148, v211
    v_exp_f32 v148, v148
    v_sub_f32 v149, v149, v211
    v_exp_f32 v149, v149
    v_sub_f32 v150, v150, v211
    v_exp_f32 v150, v150
    v_sub_f32 v151, v151, v211
    v_exp_f32 v151, v151
    v_sub_f32 v152, v152, v211
    v_exp_f32 v152, v152
    v_sub_f32 v153, v153, v211
    v_exp_f32 v153, v153
    v_sub_f32 v154, v154, v211
    v_exp_f32 v154, v154
    v_sub_f32 v155, v155, v211
    v_exp_f32 v155, v155
    v_sub_f32 v156, v156, v211
    v_exp_f32 v156, v156
    v_sub_f32 v157, v157, v211
    v_exp_f32 v157, v157
    v_sub_f32 v158, v158, v211
    v_exp_f32 v158, v158
    v_sub_f32 v159, v159, v211
    v_exp_f32 v159, v159
    v_mul_f32 v210, v210, v213
    v_mul_f32 v64, v64, v213
    v_mul_f32 v65, v65, v213
    v_mul_f32 v66, v66, v213
    v_mul_f32 v67, v67, v213
    v_mul_f32 v68, v68, v213
    v_mul_f32 v69, v69, v213
    v_mul_f32 v70, v70, v213
    v_mul_f32 v71, v71, v213
    v_mul_f32 v72, v72, v213
    v_mul_f32 v73, v73, v213
    v_mul_f32 v74, v74, v213
    v_mul_f32 v75, v75, v213
    v_mul_f32 v76, v76, v213
    v_mul_f32 v77, v77, v213
    v_mul_f32 v78, v78, v213
    v_mul_f32 v79, v79, v213
    v_mul_f32 v80, v80, v213
    v_mul_f32 v81, v81, v213
    v_mul_f32 v82, v82, v213
    v_mul_f32 v83, v83, v213
    v_mul_f32 v84, v84, v213
    v_mul_f32 v85, v85, v213
    v_mul_f32 v86, v86, v213
    v_mul_f32 v87, v87, v213
    v_mul_f32 v88, v88, v213
    v_mul_f32 v89, v89, v213
    v_mul_f32 v90, v90, v213
    v_mul_f32 v91, v91, v213
    v_mul_f32 v92, v92, v213
    v_mul_f32 v93, v93, v213
    v_mul_f32 v94, v94, v213
    v_mul_f32 v95, v95, v213
    v_mul_f32 v96, v96, v213
    v_mul_f32 v97, v97, v213
    v_mul_f32 v98, v98, v213
    v_mul_f32 v99, v99, v213
    v_mul_f32 v100, v100, v213
    v_mul_f32 v101, v101, v213
    v_mul_f32 v102, v102, v213
    v_mul_f32 v103, v103, v213
    v_mul_f32 v104, v104, v213
    v_mul_f32 v105, v105, v213
    v_mul_f32 v106, v106, v213
    v_mul_f32 v107, v107, v213
    v_mul_f32 v108, v108, v213
    v_mul_f32 v109, v109, v213
    v_mul_f32 v110, v110, v213
    v_mul_f32 v111, v111, v213
    v_mul_f32 v112, v112, v213
    v_mul_f32 v113, v113, v213
    v_mul_f32 v114, v114, v213
    v_mul_f32 v115, v115, v213
    v_mul_f32 v116, v116, v213
    v_mul_f32 v117, v117, v213
    v_mul_f32 v118, v118, v213
    v_mul_f32 v119, v119, v213
    v_mul_f32 v120, v120, v213
    v_mul_f32 v121, v121, v213
    v_mul_f32 v122, v122, v213
    v_mul_f32 v123, v123, v213
    v_mul_f32 v124, v124, v213
    v_mul_f32 v125, v125, v213
    v_mul_f32 v126, v126, v213
    v_mul_f32 v127, v127, v213
    v_add_f32 v210, v210, v128
    v_add_f32 v210, v210, v129
    v_add_f32 v210, v210, v130
    v_add_f32 v210, v210, v131
    v_add_f32 v210, v210, v132
    v_add_f32 v210, v210, v133
    v_add_f32 v210, v210, v134
    v_add_f32 v210, v210, v135
    v_add_f32 v210, v210, v136
    v_add_f32 v210, v210, v137
    v_add_f32 v210, v210, v138
    v_add_f32 v210, v210, v139
    v_add_f32 v210, v210, v140
    v_add_f32 v210, v210, v141
    v_add_f32 v210, v210, v142
    v_add_f32 v210, v210, v143
    v_add_f32 v210, v210, v144
    v_add_f32 v210, v210, v145
    v_add_f32 v210, v210, v146
    v_add_f32 v210, v210, v147
    v_add_f32 v210, v210, v148
    v_add_f32 v210, v210, v149
    v_add_f32 v210, v210, v150
    v_add_f32 v210, v210, v151
    v_add_f32 v210, v210, v152
    v_add_f32 v210, v210, v153
    v_add_f32 v210, v210, v154
    v_add_f32 v210, v210, v155
    v_add_f32 v210, v210, v156
    v_add_f32 v210, v210, v157
    v_add_f32 v210, v210, v158
    v_add_f32 v210, v210, v159
    v_cvt_pk_bf16_f32 v160, v128, v129
    v_cvt_pk_bf16_f32 v161, v130, v131
    v_cvt_pk_bf16_f32 v162, v132, v133
    v_cvt_pk_bf16_f32 v163, v134, v135
    v_cvt_pk_bf16_f32 v164, v136, v137
    v_cvt_pk_bf16_f32 v165, v138, v139
    v_cvt_pk_bf16_f32 v166, v140, v141
    v_cvt_pk_bf16_f32 v167, v142, v143
    v_cvt_pk_bf16_f32 v168, v144, v145
    v_cvt_pk_bf16_f32 v169, v146, v147
    v_cvt_pk_bf16_f32 v170, v148, v149
    v_cvt_pk_bf16_f32 v171, v150, v151
    v_cvt_pk_bf16_f32 v172, v152, v153
    v_cvt_pk_bf16_f32 v173, v154, v155
    v_cvt_pk_bf16_f32 v174, v156, v157
    v_cvt_pk_bf16_f32 v175, v158, v159
    s_waitcnt vmcnt(0)
    s_barrier
    ds_read_b64_tr_b16 v[176:176+1], v200 offset:49152
    ds_read_b64_tr_b16 v[178:178+1], v200 offset:51200
    ds_read_b64_tr_b16 v[180:180+1], v201 offset:49152
    ds_read_b64_tr_b16 v[182:182+1], v201 offset:51200
    ds_read_b64_tr_b16 v[184:184+1], v202 offset:49152
    ds_read_b64_tr_b16 v[186:186+1], v202 offset:51200
    ds_read_b64_tr_b16 v[188:188+1], v203 offset:49152
    ds_read_b64_tr_b16 v[190:190+1], v203 offset:51200
    s_waitcnt lgkmcnt(6)
    v_mfma_f32_32x32x16_bf16 v[64:79], v[176:179], v[160:163], v[64:79]
    ds_read_b64_tr_b16 v[176:176+1], v200 offset:53248
    ds_read_b64_tr_b16 v[178:178+1], v200 offset:55296
    s_waitcnt lgkmcnt(6)
    v_mfma_f32_32x32x16_bf16 v[80:95], v[180:183], v[160:163], v[80:95]
    ds_read_b64_tr_b16 v[180:180+1], v201 offset:53248
    ds_read_b64_tr_b16 v[182:182+1], v201 offset:55296
    s_waitcnt lgkmcnt(6)
    v_mfma_f32_32x32x16_bf16 v[96:111], v[184:187], v[160:163], v[96:111]
    ds_read_b64_tr_b16 v[184:184+1], v202 offset:53248
    ds_read_b64_tr_b16 v[186:186+1], v202 offset:55296
    s_waitcnt lgkmcnt(6)
    v_mfma_f32_32x32x16_bf16 v[112:127], v[188:191], v[160:163], v[112:127]
    ds_read_b64_tr_b16 v[188:188+1], v203 offset:53248
    ds_read_b64_tr_b16 v[190:190+1], v203 offset:55296
    s_waitcnt lgkmcnt(6)
    v_mfma_f32_32x32x16_bf16 v[64:79], v[176:179], v[164:167], v[64:79]
    ds_read_b64_tr_b16 v[176:176+1], v200 offset:57344
    ds_read_b64_tr_b16 v[178:178+1], v200 offset:59392
    s_waitcnt lgkmcnt(6)
    v_mfma_f32_32x32x16_bf16 v[80:95], v[180:183], v[164:167], v[80:95]
    ds_read_b64_tr_b16 v[180:180+1], v201 offset:57344
    ds_read_b64_tr_b16 v[182:182+1], v201 offset:59392
    s_waitcnt lgkmcnt(6)
    v_mfma_f32_32x32x16_bf16 v[96:111], v[184:187], v[164:167], v[96:111]
    ds_read_b64_tr_b16 v[184:184+1], v202 offset:57344
    ds_read_b64_tr_b16 v[186:186+1], v202 offset:59392
    s_waitcnt lgkmcnt(6)
    v_mfma_f32_32x32x16_bf16 v[112:127], v[188:191], v[164:167], v[112:127]
    ds_read_b64_tr_b16 v[188:188+1], v203 offset:57344
    ds_read_b64_tr_b16 v[190:190+1], v203 offset:59392
    s_waitcnt lgkmcnt(6)
    v_mfma_f32_32x32x16_bf16 v[64:79], v[176:179], v[168:171], v[64:79]
    ds_read_b64_tr_b16 v[176:176+1], v200 offset:61440
    ds_read_b64_tr_b16 v[178:178+1], v200 offset:63488
    s_waitcnt lgkmcnt(6)
    v_mfma_f32_32x32x16_bf16 v[80:95], v[180:183], v[168:171], v[80:95]
    ds_read_b64_tr_b16 v[180:180+1], v201 offset:61440
    ds_read_b64_tr_b16 v[182:182+1], v201 offset:63488
    s_waitcnt lgkmcnt(6)
    v_mfma_f32_32x32x16_bf16 v[96:111], v[184:187], v[168:171], v[96:111]
    ds_read_b64_tr_b16 v[184:184+1], v202 offset:61440
    ds_read_b64_tr_b16 v[186:186+1], v202 offset:63488
    s_waitcnt lgkmcnt(6)
    v_mfma_f32_32x32x16_bf16 v[112:127], v[188:191], v[168:171], v[112:127]
    ds_read_b64_tr_b16 v[188:188+1], v203 offset:61440
    ds_read_b64_tr_b16 v[190:190+1], v203 offset:63488
    s_waitcnt lgkmcnt(6)
    v_mfma_f32_32x32x16_bf16 v[64:79], v[176:179], v[172:175], v[64:79]
    s_waitcnt lgkmcnt(4)
    v_mfma_f32_32x32x16_bf16 v[80:95], v[180:183], v[172:175], v[80:95]
    s_waitcnt lgkmcnt(2)
    v_mfma_f32_32x32x16_bf16 v[96:111], v[184:187], v[172:175], v[96:111]
    s_waitcnt lgkmcnt(0)
    v_mfma_f32_32x32x16_bf16 v[112:127], v[188:191], v[172:175], v[112:127]
    s_nop 7
    s_nop 4
    v_mov_b32 v212, v210
    s_nop 1
    v_permlane32_swap_b32 v210, v212
    s_nop 1
    v_add_f32 v210, v210, v212
    v_rcp_f32 v210, v210
    s_nop 0
    v_mul_f32 v64, v64, v210
    v_mul_f32 v65, v65, v210
    v_mul_f32 v66, v66, v210
    v_mul_f32 v67, v67, v210
    v_mul_f32 v68, v68, v210
    v_mul_f32 v69, v69, v210
    v_mul_f32 v70, v70, v210
    v_mul_f32 v71, v71, v210
    v_mul_f32 v72, v72, v210
    v_mul_f32 v73, v73, v210
    v_mul_f32 v74, v74, v210
    v_mul_f32 v75, v75, v210
    v_mul_f32 v76, v76, v210
    v_mul_f32 v77, v77, v210
    v_mul_f32 v78, v78, v210
    v_mul_f32 v79, v79, v210
    v_mul_f32 v80, v80, v210
    v_mul_f32 v81, v81, v210
    v_mul_f32 v82, v82, v210
    v_mul_f32 v83, v83, v210
    v_mul_f32 v84, v84, v210
    v_mul_f32 v85, v85, v210
    v_mul_f32 v86, v86, v210
    v_mul_f32 v87, v87, v210
    v_mul_f32 v88, v88, v210
    v_mul_f32 v89, v89, v210
    v_mul_f32 v90, v90, v210
    v_mul_f32 v91, v91, v210
    v_mul_f32 v92, v92, v210
    v_mul_f32 v93, v93, v210
    v_mul_f32 v94, v94, v210
    v_mul_f32 v95, v95, v210
    v_mul_f32 v96, v96, v210
    v_mul_f32 v97, v97, v210
    v_mul_f32 v98, v98, v210
    v_mul_f32 v99, v99, v210
    v_mul_f32 v100, v100, v210
    v_mul_f32 v101, v101, v210
    v_mul_f32 v102, v102, v210
    v_mul_f32 v103, v103, v210
    v_mul_f32 v104, v104, v210
    v_mul_f32 v105, v105, v210
    v_mul_f32 v106, v106, v210
    v_mul_f32 v107, v107, v210
    v_mul_f32 v108, v108, v210
    v_mul_f32 v109, v109, v210
    v_mul_f32 v110, v110, v210
    v_mul_f32 v111, v111, v210
    v_mul_f32 v112, v112, v210
    v_mul_f32 v113, v113, v210
    v_mul_f32 v114, v114, v210
    v_mul_f32 v115, v115, v210
    v_mul_f32 v116, v116, v210
    v_mul_f32 v117, v117, v210
    v_mul_f32 v118, v118, v210
    v_mul_f32 v119, v119, v210
    v_mul_f32 v120, v120, v210
    v_mul_f32 v121, v121, v210
    v_mul_f32 v122, v122, v210
    v_mul_f32 v123, v123, v210
    v_mul_f32 v124, v124, v210
    v_mul_f32 v125, v125, v210
    v_mul_f32 v126, v126, v210
    v_mul_f32 v127, v127, v210
    v_cvt_pk_bf16_f32 v128, v64, v65
    v_cvt_pk_bf16_f32 v129, v66, v67
    v_cvt_pk_bf16_f32 v130, v68, v69
    v_cvt_pk_bf16_f32 v131, v70, v71
    v_cvt_pk_bf16_f32 v132, v72, v73
    v_cvt_pk_bf16_f32 v133, v74, v75
    v_cvt_pk_bf16_f32 v134, v76, v77
    v_cvt_pk_bf16_f32 v135, v78, v79
    v_cvt_pk_bf16_f32 v136, v80, v81
    v_cvt_pk_bf16_f32 v137, v82, v83
    v_cvt_pk_bf16_f32 v138, v84, v85
    v_cvt_pk_bf16_f32 v139, v86, v87
    v_cvt_pk_bf16_f32 v140, v88, v89
    v_cvt_pk_bf16_f32 v141, v90, v91
    v_cvt_pk_bf16_f32 v142, v92, v93
    v_cvt_pk_bf16_f32 v143, v94, v95
    v_cvt_pk_bf16_f32 v144, v96, v97
    v_cvt_pk_bf16_f32 v145, v98, v99
    v_cvt_pk_bf16_f32 v146, v100, v101
    v_cvt_pk_bf16_f32 v147, v102, v103
    v_cvt_pk_bf16_f32 v148, v104, v105
    v_cvt_pk_bf16_f32 v149, v106, v107
    v_cvt_pk_bf16_f32 v150, v108, v109
    v_cvt_pk_bf16_f32 v151, v110, v111
    v_cvt_pk_bf16_f32 v152, v112, v113
    v_cvt_pk_bf16_f32 v153, v114, v115
    v_cvt_pk_bf16_f32 v154, v116, v117
    v_cvt_pk_bf16_f32 v155, v118, v119
    v_cvt_pk_bf16_f32 v156, v120, v121
    v_cvt_pk_bf16_f32 v157, v122, v123
    v_cvt_pk_bf16_f32 v158, v124, v125
    v_cvt_pk_bf16_f32 v159, v126, v127
    buffer_store_dwordx2 v[128:129], v214, s[36:39], 0 offen offset:0
    buffer_store_dwordx2 v[130:131], v214, s[36:39], 0 offen offset:16
    buffer_store_dwordx2 v[132:133], v214, s[36:39], 0 offen offset:32
    buffer_store_dwordx2 v[134:135], v214, s[36:39], 0 offen offset:48
    buffer_store_dwordx2 v[136:137], v214, s[36:39], 0 offen offset:64
    buffer_store_dwordx2 v[138:139], v214, s[36:39], 0 offen offset:80
    buffer_store_dwordx2 v[140:141], v214, s[36:39], 0 offen offset:96
    buffer_store_dwordx2 v[142:143], v214, s[36:39], 0 offen offset:112
    buffer_store_dwordx2 v[144:145], v214, s[36:39], 0 offen offset:128
    buffer_store_dwordx2 v[146:147], v214, s[36:39], 0 offen offset:144
    buffer_store_dwordx2 v[148:149], v214, s[36:39], 0 offen offset:160
    buffer_store_dwordx2 v[150:151], v214, s[36:39], 0 offen offset:176
    buffer_store_dwordx2 v[152:153], v214, s[36:39], 0 offen offset:192
    buffer_store_dwordx2 v[154:155], v214, s[36:39], 0 offen offset:208
    buffer_store_dwordx2 v[156:157], v214, s[36:39], 0 offen offset:224
    buffer_store_dwordx2 v[158:159], v214, s[36:39], 0 offen offset:240
K1_exit:
    s_endpgm
K1_producer:
    v_and_b32 v20, 63, v0
    v_lshrrev_b32 v21, 4, v20
    v_and_b32 v22, 15, v20
    v_add_u32 v23, 0, v21
    v_xor_b32 v23, v23, v22
    v_lshlrev_b32 v23, 4, v23
    v_lshl_add_u32 v10, v21, 8, v23
    v_add_u32 v23, 4, v21
    v_xor_b32 v23, v23, v22
    v_lshlrev_b32 v23, 4, v23
    v_lshl_add_u32 v11, v21, 8, v23
    v_add_u32 v23, 8, v21
    v_xor_b32 v23, v23, v22
    v_lshlrev_b32 v23, 4, v23
    v_lshl_add_u32 v12, v21, 8, v23
    v_add_u32 v23, 12, v21
    v_xor_b32 v23, v23, v22
    v_lshlrev_b32 v23, 4, v23
    v_lshl_add_u32 v13, v21, 8, v23
    v_lshlrev_b32 v23, 2, v21
    v_xor_b32 v23, v23, v22
    v_lshlrev_b32 v23, 4, v23
    v_lshl_add_u32 v14, v21, 8, v23
    v_mul_u32_u24 v24, 8192, v21
    v_add_u32 v15, v24, v23
    s_lshl_b32 s44, s6, 12
    s_mul_i32 s45, s6, 131072
    s_add_u32 m0, s44, 0
    s_add_u32 s40, s45, 0
    buffer_load_dwordx4 v15, s[32:35], s40 offen offset:0 lds
    s_add_u32 s40, s45, 31744
    buffer_load_dwordx4 v15, s[32:35], s40 offen offset:1024 lds
    s_add_u32 s40, s45, 63488
    buffer_load_dwordx4 v15, s[32:35], s40 offen offset:2048 lds
    s_add_u32 s40, s45, 95232
    buffer_load_dwordx4 v15, s[32:35], s40 offen offset:3072 lds
    s_add_u32 m0, s44, 16384
    s_add_u32 s40, s45, 524288
    buffer_load_dwordx4 v15, s[32:35], s40 offen offset:0 lds
    s_add_u32 s40, s45, 556032
    buffer_load_dwordx4 v15, s[32:35], s40 offen offset:1024 lds
    s_add_u32 s40, s45, 587776
    buffer_load_dwordx4 v15, s[32:35], s40 offen offset:2048 lds
    s_add_u32 s40, s45, 619520
    buffer_load_dwordx4 v15, s[32:35], s40 offen offset:3072 lds
    s_add_u32 m0, s44, 32768
    s_add_u32 s40, s45, 1048576
    buffer_load_dwordx4 v15, s[32:35], s40 offen offset:0 lds
    s_add_u32 s40, s45, 1080320
    buffer_load_dwordx4 v15, s[32:35], s40 offen offset:1024 lds
    s_add_u32 s40, s45, 1112064
    buffer_load_dwordx4 v15, s[32:35], s40 offen offset:2048 lds
    s_add_u32 s40, s45, 1143808
    buffer_load_dwordx4 v15, s[32:35], s40 offen offset:3072 lds
    s_waitcnt vmcnt(8)
    s_barrier
    s_add_u32 m0, s44, 49152
    s_add_u32 s40, s45, 1572864
    buffer_load_dwordx4 v15, s[32:35], s40 offen offset:0 lds
    s_add_u32 s40, s45, 1604608
    buffer_load_dwordx4 v15, s[32:35], s40 offen offset:1024 lds
    s_add_u32 s40, s45, 1636352
    buffer_load_dwordx4 v15, s[32:35], s40 offen offset:2048 lds
    s_add_u32 s40, s45, 1668096
    buffer_load_dwordx4 v15, s[32:35], s40 offen offset:3072 lds
    s_waitcnt vmcnt(8)
    s_barrier
    s_add_u32 m0, s44, 0
    s_add_u32 s40, s45, 2097152
    buffer_load_dwordx4 v15, s[32:35], s40 offen offset:0 lds
    s_add_u32 s40, s45, 2128896
    buffer_load_dwordx4 v15, s[32:35], s40 offen offset:1024 lds
    s_add_u32 s40, s45, 2160640
    buffer_load_dwordx4 v15, s[32:35], s40 offen offset:2048 lds
    s_add_u32 s40, s45, 2192384
    buffer_load_dwordx4 v15, s[32:35], s40 offen offset:3072 lds
    s_waitcnt vmcnt(8)
    s_barrier
    s_add_u32 m0, s44, 16384
    s_add_u32 s40, s45, 2621440
    buffer_load_dwordx4 v15, s[32:35], s40 offen offset:0 lds
    s_add_u32 s40, s45, 2653184
    buffer_load_dwordx4 v15, s[32:35], s40 offen offset:1024 lds
    s_add_u32 s40, s45, 2684928
    buffer_load_dwordx4 v15, s[32:35], s40 offen offset:2048 lds
    s_add_u32 s40, s45, 2716672
    buffer_load_dwordx4 v15, s[32:35], s40 offen offset:3072 lds
    s_waitcnt vmcnt(8)
    s_barrier
    s_add_u32 m0, s44, 32768
    s_add_u32 s40, s45, 3145728
    buffer_load_dwordx4 v15, s[32:35], s40 offen offset:0 lds
    s_add_u32 s40, s45, 3177472
    buffer_load_dwordx4 v15, s[32:35], s40 offen offset:1024 lds
    s_add_u32 s40, s45, 3209216
    buffer_load_dwordx4 v15, s[32:35], s40 offen offset:2048 lds
    s_add_u32 s40, s45, 3240960
    buffer_load_dwordx4 v15, s[32:35], s40 offen offset:3072 lds
    s_waitcnt vmcnt(8)
    s_barrier
    s_add_u32 m0, s44, 49152
    s_add_u32 s40, s45, 3670016
    buffer_load_dwordx4 v15, s[32:35], s40 offen offset:0 lds
    s_add_u32 s40, s45, 3701760
    buffer_load_dwordx4 v15, s[32:35], s40 offen offset:1024 lds
    s_add_u32 s40, s45, 3733504
    buffer_load_dwordx4 v15, s[32:35], s40 offen offset:2048 lds
    s_add_u32 s40, s45, 3765248
    buffer_load_dwordx4 v15, s[32:35], s40 offen offset:3072 lds
    s_waitcnt vmcnt(8)
    s_barrier
    s_add_u32 m0, s44, 0
    s_add_u32 s41, s2, 0
    s_and_b32 s41, s41, 7
    s_lshl_b32 s41, s41, 14
    s_add_u32 s40, s41, s44
    buffer_load_dwordx4 v10, s[24:27], s40 offen offset:0 lds
    s_add_u32 s41, s2, 0
    s_and_b32 s41, s41, 7
    s_lshl_b32 s41, s41, 14
    s_add_u32 s40, s41, s44
    buffer_load_dwordx4 v11, s[24:27], s40 offen offset:1024 lds
    s_add_u32 s41, s2, 0
    s_and_b32 s41, s41, 7
    s_lshl_b32 s41, s41, 14
    s_add_u32 s40, s41, s44
    buffer_load_dwordx4 v12, s[24:27], s40 offen offset:2048 lds
    s_add_u32 s41, s2, 0
    s_and_b32 s41, s41, 7
    s_lshl_b32 s41, s41, 14
    s_add_u32 s40, s41, s44
    buffer_load_dwordx4 v13, s[24:27], s40 offen offset:3072 lds
    s_waitcnt vmcnt(8)
    s_barrier
    s_add_u32 m0, s44, 16384
    s_add_u32 s41, s2, 0
    s_and_b32 s41, s41, 7
    s_lshl_b32 s41, s41, 14
    s_add_u32 s40, s41, s44
    buffer_load_dwordx4 v14, s[28:31], s40 offen offset:0 lds
    s_add_u32 s41, s2, 0
    s_and_b32 s41, s41, 7
    s_lshl_b32 s41, s41, 14
    s_add_u32 s40, s41, s44
    buffer_load_dwordx4 v14, s[28:31], s40 offen offset:1024 lds
    s_add_u32 s41, s2, 0
    s_and_b32 s41, s41, 7
    s_lshl_b32 s41, s41, 14
    s_add_u32 s40, s41, s44
    buffer_load_dwordx4 v14, s[28:31], s40 offen offset:2048 lds
    s_add_u32 s41, s2, 0
    s_and_b32 s41, s41, 7
    s_lshl_b32 s41, s41, 14
    s_add_u32 s40, s41, s44
    buffer_load_dwordx4 v14, s[28:31], s40 offen offset:3072 lds
    s_waitcnt vmcnt(8)
    s_barrier
    s_add_u32 m0, s44, 32768
    s_add_u32 s41, s2, 1
    s_and_b32 s41, s41, 7
    s_lshl_b32 s41, s41, 14
    s_add_u32 s40, s41, s44
    buffer_load_dwordx4 v10, s[24:27], s40 offen offset:0 lds
    s_add_u32 s41, s2, 1
    s_and_b32 s41, s41, 7
    s_lshl_b32 s41, s41, 14
    s_add_u32 s40, s41, s44
    buffer_load_dwordx4 v11, s[24:27], s40 offen offset:1024 lds
    s_add_u32 s41, s2, 1
    s_and_b32 s41, s41, 7
    s_lshl_b32 s41, s41, 14
    s_add_u32 s40, s41, s44
    buffer_load_dwordx4 v12, s[24:27], s40 offen offset:2048 lds
    s_add_u32 s41, s2, 1
    s_and_b32 s41, s41, 7
    s_lshl_b32 s41, s41, 14
    s_add_u32 s40, s41, s44
    buffer_load_dwordx4 v13, s[24:27], s40 offen offset:3072 lds
    s_waitcnt vmcnt(8)
    s_barrier
    s_add_u32 m0, s44, 49152
    s_add_u32 s41, s2, 1
    s_and_b32 s41, s41, 7
    s_lshl_b32 s41, s41, 14
    s_add_u32 s40, s41, s44
    buffer_load_dwordx4 v14, s[28:31], s40 offen offset:0 lds
    s_add_u32 s41, s2, 1
    s_and_b32 s41, s41, 7
    s_lshl_b32 s41, s41, 14
    s_add_u32 s40, s41, s44
    buffer_load_dwordx4 v14, s[28:31], s40 offen offset:1024 lds
    s_add_u32 s41, s2, 1
    s_and_b32 s41, s41, 7
    s_lshl_b32 s41, s41, 14
    s_add_u32 s40, s41, s44
    buffer_load_dwordx4 v14, s[28:31], s40 offen offset:2048 lds
    s_add_u32 s41, s2, 1
    s_and_b32 s41, s41, 7
    s_lshl_b32 s41, s41, 14
    s_add_u32 s40, s41, s44
    buffer_load_dwordx4 v14, s[28:31], s40 offen offset:3072 lds
    s_waitcnt vmcnt(8)
    s_barrier
    s_add_u32 m0, s44, 0
    s_add_u32 s41, s2, 2
    s_and_b32 s41, s41, 7
    s_lshl_b32 s41, s41, 14
    s_add_u32 s40, s41, s44
    buffer_load_dwordx4 v10, s[24:27], s40 offen offset:0 lds
    s_add_u32 s41, s2, 2
    s_and_b32 s41, s41, 7
    s_lshl_b32 s41, s41, 14
    s_add_u32 s40, s41, s44
    buffer_load_dwordx4 v11, s[24:27], s40 offen offset:1024 lds
    s_add_u32 s41, s2, 2
    s_and_b32 s41, s41, 7
    s_lshl_b32 s41, s41, 14
    s_add_u32 s40, s41, s44
    buffer_load_dwordx4 v12, s[24:27], s40 offen offset:2048 lds
    s_add_u32 s41, s2, 2
    s_and_b32 s41, s41, 7
    s_lshl_b32 s41, s41, 14
    s_add_u32 s40, s41, s44
    buffer_load_dwordx4 v13, s[24:27], s40 offen offset:3072 lds
    s_waitcnt vmcnt(8)
    s_barrier
    s_add_u32 m0, s44, 16384
    s_add_u32 s41, s2, 2
    s_and_b32 s41, s41, 7
    s_lshl_b32 s41, s41, 14
    s_add_u32 s40, s41, s44
    buffer_load_dwordx4 v14, s[28:31], s40 offen offset:0 lds
    s_add_u32 s41, s2, 2
    s_and_b32 s41, s41, 7
    s_lshl_b32 s41, s41, 14
    s_add_u32 s40, s41, s44
    buffer_load_dwordx4 v14, s[28:31], s40 offen offset:1024 lds
    s_add_u32 s41, s2, 2
    s_and_b32 s41, s41, 7
    s_lshl_b32 s41, s41, 14
    s_add_u32 s40, s41, s44
    buffer_load_dwordx4 v14, s[28:31], s40 offen offset:2048 lds
    s_add_u32 s41, s2, 2
    s_and_b32 s41, s41, 7
    s_lshl_b32 s41, s41, 14
    s_add_u32 s40, s41, s44
    buffer_load_dwordx4 v14, s[28:31], s40 offen offset:3072 lds
    s_waitcnt vmcnt(8)
    s_barrier
    s_add_u32 m0, s44, 32768
    s_add_u32 s41, s2, 3
    s_and_b32 s41, s41, 7
    s_lshl_b32 s41, s41, 14
    s_add_u32 s40, s41, s44
    buffer_load_dwordx4 v10, s[24:27], s40 offen offset:0 lds
    s_add_u32 s41, s2, 3
    s_and_b32 s41, s41, 7
    s_lshl_b32 s41, s41, 14
    s_add_u32 s40, s41, s44
    buffer_load_dwordx4 v11, s[24:27], s40 offen offset:1024 lds
    s_add_u32 s41, s2, 3
    s_and_b32 s41, s41, 7
    s_lshl_b32 s41, s41, 14
    s_add_u32 s40, s41, s44
    buffer_load_dwordx4 v12, s[24:27], s40 offen offset:2048 lds
    s_add_u32 s41, s2, 3
    s_and_b32 s41, s41, 7
    s_lshl_b32 s41, s41, 14
    s_add_u32 s40, s41, s44
    buffer_load_dwordx4 v13, s[24:27], s40 offen offset:3072 lds
    s_waitcnt vmcnt(8)
    s_barrier
    s_add_u32 m0, s44, 49152
    s_add_u32 s41, s2, 3
    s_and_b32 s41, s41, 7
    s_lshl_b32 s41, s41, 14
    s_add_u32 s40, s41, s44
    buffer_load_dwordx4 v14, s[28:31], s40 offen offset:0 lds
    s_add_u32 s41, s2, 3
    s_and_b32 s41, s41, 7
    s_lshl_b32 s41, s41, 14
    s_add_u32 s40, s41, s44
    buffer_load_dwordx4 v14, s[28:31], s40 offen offset:1024 lds
    s_add_u32 s41, s2, 3
    s_and_b32 s41, s41, 7
    s_lshl_b32 s41, s41, 14
    s_add_u32 s40, s41, s44
    buffer_load_dwordx4 v14, s[28:31], s40 offen offset:2048 lds
    s_add_u32 s41, s2, 3
    s_and_b32 s41, s41, 7
    s_lshl_b32 s41, s41, 14
    s_add_u32 s40, s41, s44
    buffer_load_dwordx4 v14, s[28:31], s40 offen offset:3072 lds
    s_waitcnt vmcnt(8)
    s_barrier
    s_add_u32 m0, s44, 0
    s_add_u32 s41, s2, 4
    s_and_b32 s41, s41, 7
    s_lshl_b32 s41, s41, 14
    s_add_u32 s40, s41, s44
    buffer_load_dwordx4 v10, s[24:27], s40 offen offset:0 lds
    s_add_u32 s41, s2, 4
    s_and_b32 s41, s41, 7
    s_lshl_b32 s41, s41, 14
    s_add_u32 s40, s41, s44
    buffer_load_dwordx4 v11, s[24:27], s40 offen offset:1024 lds
    s_add_u32 s41, s2, 4
    s_and_b32 s41, s41, 7
    s_lshl_b32 s41, s41, 14
    s_add_u32 s40, s41, s44
    buffer_load_dwordx4 v12, s[24:27], s40 offen offset:2048 lds
    s_add_u32 s41, s2, 4
    s_and_b32 s41, s41, 7
    s_lshl_b32 s41, s41, 14
    s_add_u32 s40, s41, s44
    buffer_load_dwordx4 v13, s[24:27], s40 offen offset:3072 lds
    s_waitcnt vmcnt(8)
    s_barrier
    s_add_u32 m0, s44, 16384
    s_add_u32 s41, s2, 4
    s_and_b32 s41, s41, 7
    s_lshl_b32 s41, s41, 14
    s_add_u32 s40, s41, s44
    buffer_load_dwordx4 v14, s[28:31], s40 offen offset:0 lds
    s_add_u32 s41, s2, 4
    s_and_b32 s41, s41, 7
    s_lshl_b32 s41, s41, 14
    s_add_u32 s40, s41, s44
    buffer_load_dwordx4 v14, s[28:31], s40 offen offset:1024 lds
    s_add_u32 s41, s2, 4
    s_and_b32 s41, s41, 7
    s_lshl_b32 s41, s41, 14
    s_add_u32 s40, s41, s44
    buffer_load_dwordx4 v14, s[28:31], s40 offen offset:2048 lds
    s_add_u32 s41, s2, 4
    s_and_b32 s41, s41, 7
    s_lshl_b32 s41, s41, 14
    s_add_u32 s40, s41, s44
    buffer_load_dwordx4 v14, s[28:31], s40 offen offset:3072 lds
    s_waitcnt vmcnt(8)
    s_barrier
    s_add_u32 m0, s44, 32768
    s_add_u32 s41, s2, 5
    s_and_b32 s41, s41, 7
    s_lshl_b32 s41, s41, 14
    s_add_u32 s40, s41, s44
    buffer_load_dwordx4 v10, s[24:27], s40 offen offset:0 lds
    s_add_u32 s41, s2, 5
    s_and_b32 s41, s41, 7
    s_lshl_b32 s41, s41, 14
    s_add_u32 s40, s41, s44
    buffer_load_dwordx4 v11, s[24:27], s40 offen offset:1024 lds
    s_add_u32 s41, s2, 5
    s_and_b32 s41, s41, 7
    s_lshl_b32 s41, s41, 14
    s_add_u32 s40, s41, s44
    buffer_load_dwordx4 v12, s[24:27], s40 offen offset:2048 lds
    s_add_u32 s41, s2, 5
    s_and_b32 s41, s41, 7
    s_lshl_b32 s41, s41, 14
    s_add_u32 s40, s41, s44
    buffer_load_dwordx4 v13, s[24:27], s40 offen offset:3072 lds
    s_waitcnt vmcnt(8)
    s_barrier
    s_add_u32 m0, s44, 49152
    s_add_u32 s41, s2, 5
    s_and_b32 s41, s41, 7
    s_lshl_b32 s41, s41, 14
    s_add_u32 s40, s41, s44
    buffer_load_dwordx4 v14, s[28:31], s40 offen offset:0 lds
    s_add_u32 s41, s2, 5
    s_and_b32 s41, s41, 7
    s_lshl_b32 s41, s41, 14
    s_add_u32 s40, s41, s44
    buffer_load_dwordx4 v14, s[28:31], s40 offen offset:1024 lds
    s_add_u32 s41, s2, 5
    s_and_b32 s41, s41, 7
    s_lshl_b32 s41, s41, 14
    s_add_u32 s40, s41, s44
    buffer_load_dwordx4 v14, s[28:31], s40 offen offset:2048 lds
    s_add_u32 s41, s2, 5
    s_and_b32 s41, s41, 7
    s_lshl_b32 s41, s41, 14
    s_add_u32 s40, s41, s44
    buffer_load_dwordx4 v14, s[28:31], s40 offen offset:3072 lds
    s_waitcnt vmcnt(8)
    s_barrier
    s_add_u32 m0, s44, 0
    s_add_u32 s41, s2, 6
    s_and_b32 s41, s41, 7
    s_lshl_b32 s41, s41, 14
    s_add_u32 s40, s41, s44
    buffer_load_dwordx4 v10, s[24:27], s40 offen offset:0 lds
    s_add_u32 s41, s2, 6
    s_and_b32 s41, s41, 7
    s_lshl_b32 s41, s41, 14
    s_add_u32 s40, s41, s44
    buffer_load_dwordx4 v11, s[24:27], s40 offen offset:1024 lds
    s_add_u32 s41, s2, 6
    s_and_b32 s41, s41, 7
    s_lshl_b32 s41, s41, 14
    s_add_u32 s40, s41, s44
    buffer_load_dwordx4 v12, s[24:27], s40 offen offset:2048 lds
    s_add_u32 s41, s2, 6
    s_and_b32 s41, s41, 7
    s_lshl_b32 s41, s41, 14
    s_add_u32 s40, s41, s44
    buffer_load_dwordx4 v13, s[24:27], s40 offen offset:3072 lds
    s_waitcnt vmcnt(8)
    s_barrier
    s_add_u32 m0, s44, 16384
    s_add_u32 s41, s2, 6
    s_and_b32 s41, s41, 7
    s_lshl_b32 s41, s41, 14
    s_add_u32 s40, s41, s44
    buffer_load_dwordx4 v14, s[28:31], s40 offen offset:0 lds
    s_add_u32 s41, s2, 6
    s_and_b32 s41, s41, 7
    s_lshl_b32 s41, s41, 14
    s_add_u32 s40, s41, s44
    buffer_load_dwordx4 v14, s[28:31], s40 offen offset:1024 lds
    s_add_u32 s41, s2, 6
    s_and_b32 s41, s41, 7
    s_lshl_b32 s41, s41, 14
    s_add_u32 s40, s41, s44
    buffer_load_dwordx4 v14, s[28:31], s40 offen offset:2048 lds
    s_add_u32 s41, s2, 6
    s_and_b32 s41, s41, 7
    s_lshl_b32 s41, s41, 14
    s_add_u32 s40, s41, s44
    buffer_load_dwordx4 v14, s[28:31], s40 offen offset:3072 lds
    s_waitcnt vmcnt(8)
    s_barrier
    s_add_u32 m0, s44, 32768
    s_add_u32 s41, s2, 7
    s_and_b32 s41, s41, 7
    s_lshl_b32 s41, s41, 14
    s_add_u32 s40, s41, s44
    buffer_load_dwordx4 v10, s[24:27], s40 offen offset:0 lds
    s_add_u32 s41, s2, 7
    s_and_b32 s41, s41, 7
    s_lshl_b32 s41, s41, 14
    s_add_u32 s40, s41, s44
    buffer_load_dwordx4 v11, s[24:27], s40 offen offset:1024 lds
    s_add_u32 s41, s2, 7
    s_and_b32 s41, s41, 7
    s_lshl_b32 s41, s41, 14
    s_add_u32 s40, s41, s44
    buffer_load_dwordx4 v12, s[24:27], s40 offen offset:2048 lds
    s_add_u32 s41, s2, 7
    s_and_b32 s41, s41, 7
    s_lshl_b32 s41, s41, 14
    s_add_u32 s40, s41, s44
    buffer_load_dwordx4 v13, s[24:27], s40 offen offset:3072 lds
    s_waitcnt vmcnt(8)
    s_barrier
    s_add_u32 m0, s44, 49152
    s_add_u32 s41, s2, 7
    s_and_b32 s41, s41, 7
    s_lshl_b32 s41, s41, 14
    s_add_u32 s40, s41, s44
    buffer_load_dwordx4 v14, s[28:31], s40 offen offset:0 lds
    s_add_u32 s41, s2, 7
    s_and_b32 s41, s41, 7
    s_lshl_b32 s41, s41, 14
    s_add_u32 s40, s41, s44
    buffer_load_dwordx4 v14, s[28:31], s40 offen offset:1024 lds
    s_add_u32 s41, s2, 7
    s_and_b32 s41, s41, 7
    s_lshl_b32 s41, s41, 14
    s_add_u32 s40, s41, s44
    buffer_load_dwordx4 v14, s[28:31], s40 offen offset:2048 lds
    s_add_u32 s41, s2, 7
    s_and_b32 s41, s41, 7
    s_lshl_b32 s41, s41, 14
    s_add_u32 s40, s41, s44
    buffer_load_dwordx4 v14, s[28:31], s40 offen offset:3072 lds
    s_waitcnt vmcnt(8)
    s_barrier
    s_waitcnt vmcnt(4)
    s_barrier
    s_waitcnt vmcnt(0)
    s_barrier
    s_endpgm
.globl oproj_kernel
.p2align 8
.type oproj_kernel,@function
oproj_kernel:
    s_cmp_ge_u32 s2, 256
    s_cbranch_scc1 K2_exit
    s_and_b32 s3, s2, 3
    s_bfe_u32 s4, s2, 0x20002
    s_bfe_u32 s5, s2, 0x30004
    s_lshr_b32 s7, s2, 7
    s_mul_i32 s40, s7, 40
    s_add_u32 s42, s0, s40
    s_addc_u32 s43, s1, 0
    s_load_dwordx2 s[14:15], s[42:43], 32
    s_load_dwordx2 s[16:17], s[0:1], 96
    v_lshrrev_b32 v1, 6, v0
    s_nop 0
    v_readfirstlane_b32 s6, v1
    s_waitcnt lgkmcnt(0)
    s_lshl_b32 s41, s7, 3
    s_add_u32 s41, s41, s5
    s_mul_i32 s41, s41, 786432
    s_lshl_b32 s40, s3, 11
    s_add_u32 s41, s41, s40
    s_add_u32 s8, s16, s41
    s_addc_u32 s9, s17, 0
    s_sub_u32 s41, 786432, s40
    s_mov_b32 s20, s8
    s_and_b32 s21, s9, 0xffff
    s_mov_b32 s22, s41
    s_mov_b32 s23, 0x20000
    s_lshl_b32 s40, s3, 20
    s_lshl_b32 s41, s4, 8
    s_add_u32 s40, s40, s41
    s_add_u32 s14, s14, s40
    s_addc_u32 s15, s15, 0
    s_sub_u32 s41, 4194304, s40
    s_mov_b32 s32, s14
    s_and_b32 s33, s15, 0xffff
    s_mov_b32 s34, s41
    s_mov_b32 s35, 0x20000
    s_lshl_b32 s41, s3, 1
    s_add_u32 s41, s41, s7
    s_lshl_b32 s41, s41, 3
    s_add_u32 s41, s41, s5
    s_mul_i32 s41, s41, 196608
    s_lshl_b32 s40, s4, 9
    s_add_u32 s41, s41, s40
    s_add_u32 s41, s41, 16777216
    s_add_u32 s16, s16, s41
    s_addc_u32 s17, s17, 0
    s_sub_u32 s41, 196608, s40
    s_mov_b32 s36, s16
    s_and_b32 s37, s17, 0xffff
    s_mov_b32 s38, s41
    s_mov_b32 s39, 0x20000
    s_cmp_eq_u32 s6, 3
    s_cbranch_scc1 K2_producer
    v_and_b32 v1, 63, v0
    v_and_b32 v2, 31, v1
    v_lshrrev_b32 v3, 5, v1
    v_bfe_u32 v4, v1, 4, 1
    v_bfe_u32 v5, v1, 2, 2
    v_and_b32 v6, 3, v1
    v_lshrrev_b32 v7, 1, v6
    v_and_b32 v8, 1, v6
    v_lshl_add_u32 v7, v4, 1, v7
    v_mul_u32_u24 v9, 8, v3
    v_add_u32 v9, v9, v5
    v_lshlrev_b32 v9, 8, v9
    v_lshl_add_u32 v9, v8, 3, v9
    v_lshlrev_b32 v8, 2, v5
    v_add_u32 v204, 0, v7
    v_xor_b32 v204, v204, v8
    v_lshl_add_u32 v204, v204, 4, v9
    v_add_u32 v205, 4, v7
    v_xor_b32 v205, v205, v8
    v_lshl_add_u32 v205, v205, 4, v9
    v_add_u32 v206, 8, v7
    v_xor_b32 v206, v206, v8
    v_lshl_add_u32 v206, v206, 4, v9
    v_add_u32 v207, 12, v7
    v_xor_b32 v207, v207, v8
    v_lshl_add_u32 v207, v207, 4, v9
    s_lshl_b32 s40, s6, 5
    v_add_u32 v7, s40, v2
    v_lshlrev_b32 v208, 13, v7
    v_lshl_add_u32 v208, v3, 4, v208
    v_lshlrev_b32 v214, 11, v7
    v_lshl_add_u32 v214, v3, 4, v214
    v_and_b32 v20, 63, v0
    v_lshrrev_b32 v21, 4, v20
    v_and_b32 v22, 15, v20
    v_add_u32 v23, 0, v21
    v_xor_b32 v23, v23, v22
    v_lshlrev_b32 v23, 4, v23
    v_lshl_add_u32 v216, v21, 8, v23
    v_add_u32 v23, 4, v21
    v_xor_b32 v23, v23, v22
    v_lshlrev_b32 v23, 4, v23
    v_lshl_add_u32 v217, v21, 8, v23
    v_add_u32 v23, 8, v21
    v_xor_b32 v23, v23, v22
    v_lshlrev_b32 v23, 4, v23
    v_lshl_add_u32 v218, v21, 8, v23
    v_add_u32 v23, 12, v21
    v_xor_b32 v23, v23, v22
    v_lshlrev_b32 v23, 4, v23
    v_lshl_add_u32 v219, v21, 8, v23
    v_lshlrev_b32 v23, 2, v21
    v_xor_b32 v23, v23, v22
    v_lshlrev_b32 v23, 4, v23
    v_lshl_add_u32 v220, v21, 8, v23
    v_mul_u32_u24 v24, 1024, v21
    v_add_u32 v221, v24, v23
    s_lshl_b32 s44, s6, 12
    s_mul_i32 s45, s6, 16384
    s_add_u32 m0, s44, 0
    s_add_u32 s40, s45, 0
    buffer_load_dwordx4 v221, s[32:35], s40 offen offset:0 lds
    s_add_u32 s40, s45, 3072
    buffer_load_dwordx4 v221, s[32:35], s40 offen offset:1024 lds
    s_add_u32 s40, s45, 6144
    buffer_load_dwordx4 v221, s[32:35], s40 offen offset:2048 lds
    s_add_u32 s40, s45, 9216
    buffer_load_dwordx4 v221, s[32:35], s40 offen offset:3072 lds
    s_add_u32 m0, s44, 16384
    s_add_u32 s40, s45, 65536
    buffer_load_dwordx4 v221, s[32:35], s40 offen offset:0 lds
    s_add_u32 s40, s45, 68608
    buffer_load_dwordx4 v221, s[32:35], s40 offen offset:1024 lds
    s_add_u32 s40, s45, 71680
    buffer_load_dwordx4 v221, s[32:35], s40 offen offset:2048 lds
    s_add_u32 s40, s45, 74752
    buffer_load_dwordx4 v221, s[32:35], s40 offen offset:3072 lds
    s_add_u32 m0, s44, 32768
    s_add_u32 s40, s45, 131072
    buffer_load_dwordx4 v221, s[32:35], s40 offen offset:0 lds
    s_add_u32 s40, s45, 134144
    buffer_load_dwordx4 v221, s[32:35], s40 offen offset:1024 lds
    s_add_u32 s40, s45, 137216
    buffer_load_dwordx4 v221, s[32:35], s40 offen offset:2048 lds
    s_add_u32 s40, s45, 140288
    buffer_load_dwordx4 v221, s[32:35], s40 offen offset:3072 lds
    buffer_load_dwordx4 v[128:131], v208, s[20:23], 0 offen offset:0
    buffer_load_dwordx4 v[132:135], v208, s[20:23], 0 offen offset:32
    buffer_load_dwordx4 v[136:139], v208, s[20:23], 0 offen offset:64
    buffer_load_dwordx4 v[140:143], v208, s[20:23], 0 offen offset:96
    s_waitcnt vmcnt(12)
    s_barrier
    buffer_load_dwordx4 v[144:147], v208, s[20:23], 0 offen offset:128
    buffer_load_dwordx4 v[148:151], v208, s[20:23], 0 offen offset:160
    buffer_load_dwordx4 v[152:155], v208, s[20:23], 0 offen offset:192
    buffer_load_dwordx4 v[156:159], v208, s[20:23], 0 offen offset:224
    s_add_u32 m0, s44, 49152
    s_add_u32 s40, s45, 196608
    buffer_load_dwordx4 v221, s[32:35], s40 offen offset:0 lds
    s_add_u32 s40, s45, 199680
    buffer_load_dwordx4 v221, s[32:35], s40 offen offset:1024 lds
    s_add_u32 s40, s45, 202752
    buffer_load_dwordx4 v221, s[32:35], s40 offen offset:2048 lds
    s_add_u32 s40, s45, 205824
    buffer_load_dwordx4 v221, s[32:35], s40 offen offset:3072 lds
    s_waitcnt vmcnt(8)
    ds_read_b64_tr_b16 v[176:176+1], v204 offset:0
    ds_read_b64_tr_b16 v[178:178+1], v204 offset:1024
    ds_read_b64_tr_b16 v[180:180+1], v205 offset:0
    ds_read_b64_tr_b16 v[182:182+1], v205 offset:1024
    ds_read_b64_tr_b16 v[184:184+1], v206 offset:0
    ds_read_b64_tr_b16 v[186:186+1], v206 offset:1024
    ds_read_b64_tr_b16 v[188:188+1], v207 offset:0
    ds_read_b64_tr_b16 v[190:190+1], v207 offset:1024
    s_waitcnt lgkmcnt(6)
    v_mfma_f32_32x32x16_bf16 v[64:79], v[176:179], v[128:131], 0
    ds_read_b64_tr_b16 v[176:176+1], v204 offset:4096
    ds_read_b64_tr_b16 v[178:178+1], v204 offset:5120
    s_waitcnt lgkmcnt(6)
    v_mfma_f32_32x32x16_bf16 v[80:95], v[180:183], v[128:131], 0
    ds_read_b64_tr_b16 v[180:180+1], v205 offset:4096
    ds_read_b64_tr_b16 v[182:182+1], v205 offset:5120
    s_waitcnt lgkmcnt(6)
    v_mfma_f32_32x32x16_bf16 v[96:111], v[184:187], v[128:131], 0
    ds_read_b64_tr_b16 v[184:184+1], v206 offset:4096
    ds_read_b64_tr_b16 v[186:186+1], v206 offset:5120
    s_waitcnt lgkmcnt(6)
    v_mfma_f32_32x32x16_bf16 v[112:127], v[188:191], v[128:131], 0
    ds_read_b64_tr_b16 v[188:188+1], v207 offset:4096
    ds_read_b64_tr_b16 v[190:190+1], v207 offset:5120
    s_waitcnt lgkmcnt(6)
    v_mfma_f32_32x32x16_bf16 v[64:79], v[176:179], v[132:135], v[64:79]
    ds_read_b64_tr_b16 v[176:176+1], v204 offset:8192
    ds_read_b64_tr_b16 v[178:178+1], v204 offset:9216
    s_waitcnt lgkmcnt(6)
    v_mfma_f32_32x32x16_bf16 v[80:95], v[180:183], v[132:135], v[80:95]
    ds_read_b64_tr_b16 v[180:180+1], v205 offset:8192
    ds_read_b64_tr_b16 v[182:182+1], v205 offset:9216
    s_waitcnt lgkmcnt(6)
    v_mfma_f32_32x32x16_bf16 v[96:111], v[184:187], v[132:135], v[96:111]
    ds_read_b64_tr_b16 v[184:184+1], v206 offset:8192
    ds_read_b64_tr_b16 v[186:186+1], v206 offset:9216
    s_waitcnt lgkmcnt(6)
    v_mfma_f32_32x32x16_bf16 v[112:127], v[188:191], v[132:135], v[112:127]
    ds_read_b64_tr_b16 v[188:188+1], v207 offset:8192
    ds_read_b64_tr_b16 v[190:190+1], v207 offset:9216
    s_waitcnt lgkmcnt(6)
    v_mfma_f32_32x32x16_bf16 v[64:79], v[176:179], v[136:139], v[64:79]
    ds_read_b64_tr_b16 v[176:176+1], v204 offset:12288
    ds_read_b64_tr_b16 v[178:178+1], v204 offset:13312
    s_waitcnt lgkmcnt(6)
    v_mfma_f32_32x32x16_bf16 v[80:95], v[180:183], v[136:139], v[80:95]
    ds_read_b64_tr_b16 v[180:180+1], v205 offset:12288
    ds_read_b64_tr_b16 v[182:182+1], v205 offset:13312
    s_waitcnt lgkmcnt(6)
    v_mfma_f32_32x32x16_bf16 v[96:111], v[184:187], v[136:139], v[96:111]
    ds_read_b64_tr_b16 v[184:184+1], v206 offset:12288
    ds_read_b64_tr_b16 v[186:186+1], v206 offset:13312
    s_waitcnt lgkmcnt(6)
    v_mfma_f32_32x32x16_bf16 v[112:127], v[188:191], v[136:139], v[112:127]
    ds_read_b64_tr_b16 v[188:188+1], v207 offset:12288
    ds_read_b64_tr_b16 v[190:190+1], v207 offset:13312
    s_waitcnt lgkmcnt(6)
    v_mfma_f32_32x32x16_bf16 v[64:79], v[176:179], v[140:143], v[64:79]
    s_waitcnt lgkmcnt(4)
    v_mfma_f32_32x32x16_bf16 v[80:95], v[180:183], v[140:143], v[80:95]
    s_waitcnt lgkmcnt(2)
    v_mfma_f32_32x32x16_bf16 v[96:111], v[184:187], v[140:143], v[96:111]
    s_waitcnt lgkmcnt(0)
    v_mfma_f32_32x32x16_bf16 v[112:127], v[188:191], v[140:143], v[112:127]
    s_waitcnt vmcnt(16)
    s_barrier
    buffer_load_dwordx4 v[128:131], v208, s[20:23], 0 offen offset:256
    buffer_load_dwordx4 v[132:135], v208, s[20:23], 0 offen offset:288
    buffer_load_dwordx4 v[136:139], v208, s[20:23], 0 offen offset:320
    buffer_load_dwordx4 v[140:143], v208, s[20:23], 0 offen offset:352
    s_add_u32 m0, s44, 0
    s_add_u32 s40, s45, 262144
    buffer_load_dwordx4 v221, s[32:35], s40 offen offset:0 lds
    s_add_u32 s40, s45, 265216
    buffer_load_dwordx4 v221, s[32:35], s40 offen offset:1024 lds
    s_add_u32 s40, s45, 268288
    buffer_load_dwordx4 v221, s[32:35], s40 offen offset:2048 lds
    s_add_u32 s40, s45, 271360
    buffer_load_dwordx4 v221, s[32:35], s40 offen offset:3072 lds
    s_waitcnt vmcnt(12)
    ds_read_b64_tr_b16 v[176:176+1], v204 offset:16384
    ds_read_b64_tr_b16 v[178:178+1], v204 offset:17408
    ds_read_b64_tr_b16 v[180:180+1], v205 offset:16384
    ds_read_b64_tr_b16 v[182:182+1], v205 offset:17408
    ds_read_b64_tr_b16 v[184:184+1], v206 offset:16384
    ds_read_b64_tr_b16 v[186:186+1], v206 offset:17408
    ds_read_b64_tr_b16 v[188:188+1], v207 offset:16384
    ds_read_b64_tr_b16 v[190:190+1], v207 offset:17408
    s_waitcnt lgkmcnt(6)
    v_mfma_f32_32x32x16_bf16 v[64:79], v[176:179], v[144:147], v[64:79]
    ds_read_b64_tr_b16 v[176:176+1], v204 offset:20480
    ds_read_b64_tr_b16 v[178:178+1], v204 offset:21504
    s_waitcnt lgkmcnt(6)
    v_mfma_f32_32x32x16_bf16 v[80:95], v[180:183], v[144:147], v[80:95]
    ds_read_b64_tr_b16 v[180:180+1], v205 offset:20480
    ds_read_b64_tr_b16 v[182:182+1], v205 offset:21504
    s_waitcnt lgkmcnt(6)
    v_mfma_f32_32x32x16_bf16 v[96:111], v[184:187], v[144:147], v[96:111]
    ds_read_b64_tr_b16 v[184:184+1], v206 offset:20480
    ds_read_b64_tr_b16 v[186:186+1], v206 offset:21504
    s_waitcnt lgkmcnt(6)
    v_mfma_f32_32x32x16_bf16 v[112:127], v[188:191], v[144:147], v[112:127]
    ds_read_b64_tr_b16 v[188:188+1], v207 offset:20480
    ds_read_b64_tr_b16 v[190:190+1], v207 offset:21504
    s_waitcnt lgkmcnt(6)
    v_mfma_f32_32x32x16_bf16 v[64:79], v[176:179], v[148:151], v[64:79]
    ds_read_b64_tr_b16 v[176:176+1], v204 offset:24576
    ds_read_b64_tr_b16 v[178:178+1], v204 offset:25600
    s_waitcnt lgkmcnt(6)
    v_mfma_f32_32x32x16_bf16 v[80:95], v[180:183], v[148:151], v[80:95]
    ds_read_b64_tr_b16 v[180:180+1], v205 offset:24576
    ds_read_b64_tr_b16 v[182:182+1], v205 offset:25600
    s_waitcnt lgkmcnt(6)
    v_mfma_f32_32x32x16_bf16 v[96:111], v[184:187], v[148:151], v[96:111]
    ds_read_b64_tr_b16 v[184:184+1], v206 offset:24576
    ds_read_b64_tr_b16 v[186:186+1], v206 offset:25600
    s_waitcnt lgkmcnt(6)
    v_mfma_f32_32x32x16_bf16 v[112:127], v[188:191], v[148:151], v[112:127]
    ds_read_b64_tr_b16 v[188:188+1], v207 offset:24576
    ds_read_b64_tr_b16 v[190:190+1], v207 offset:25600
    s_waitcnt lgkmcnt(6)
    v_mfma_f32_32x32x16_bf16 v[64:79], v[176:179], v[152:155], v[64:79]
    ds_read_b64_tr_b16 v[176:176+1], v204 offset:28672
    ds_read_b64_tr_b16 v[178:178+1], v204 offset:29696
    s_waitcnt lgkmcnt(6)
    v_mfma_f32_32x32x16_bf16 v[80:95], v[180:183], v[152:155], v[80:95]
    ds_read_b64_tr_b16 v[180:180+1], v205 offset:28672
    ds_read_b64_tr_b16 v[182:182+1], v205 offset:29696
    s_waitcnt lgkmcnt(6)
    v_mfma_f32_32x32x16_bf16 v[96:111], v[184:187], v[152:155], v[96:111]
    ds_read_b64_tr_b16 v[184:184+1], v206 offset:28672
    ds_read_b64_tr_b16 v[186:186+1], v206 offset:29696
    s_waitcnt lgkmcnt(6)
    v_mfma_f32_32x32x16_bf16 v[112:127], v[188:191], v[152:155], v[112:127]
    ds_read_b64_tr_b16 v[188:188+1], v207 offset:28672
    ds_read_b64_tr_b16 v[190:190+1], v207 offset:29696
    s_waitcnt lgkmcnt(6)
    v_mfma_f32_32x32x16_bf16 v[64:79], v[176:179], v[156:159], v[64:79]
    s_waitcnt lgkmcnt(4)
    v_mfma_f32_32x32x16_bf16 v[80:95], v[180:183], v[156:159], v[80:95]
    s_waitcnt lgkmcnt(2)
    v_mfma_f32_32x32x16_bf16 v[96:111], v[184:187], v[156:159], v[96:111]
    s_waitcnt lgkmcnt(0)
    v_mfma_f32_32x32x16_bf16 v[112:127], v[188:191], v[156:159], v[112:127]
    s_waitcnt vmcnt(20)
    s_barrier
    buffer_load_dwordx4 v[144:147], v208, s[20:23], 0 offen offset:384
    buffer_load_dwordx4 v[148:151], v208, s[20:23], 0 offen offset:416
    buffer_load_dwordx4 v[152:155], v208, s[20:23], 0 offen offset:448
    buffer_load_dwordx4 v[156:159], v208, s[20:23], 0 offen offset:480
    s_add_u32 m0, s44, 16384
    s_add_u32 s40, s45, 327680
    buffer_load_dwordx4 v221, s[32:35], s40 offen offset:0 lds
    s_add_u32 s40, s45, 330752
    buffer_load_dwordx4 v221, s[32:35], s40 offen offset:1024 lds
    s_add_u32 s40, s45, 333824
    buffer_load_dwordx4 v221, s[32:35], s40 offen offset:2048 lds
    s_add_u32 s40, s45, 336896
    buffer_load_dwordx4 v221, s[32:35], s40 offen offset:3072 lds
    s_waitcnt vmcnt(12)
    ds_read_b64_tr_b16 v[176:176+1], v204 offset:32768
    ds_read_b64_tr_b16 v[178:178+1], v204 offset:33792
    ds_read_b64_tr_b16 v[180:180+1], v205 offset:32768
    ds_read_b64_tr_b16 v[182:182+1], v205 offset:33792
    ds_read_b64_tr_b16 v[184:184+1], v206 offset:32768
    ds_read_b64_tr_b16 v[186:186+1], v206 offset:33792
    ds_read_b64_tr_b16 v[188:188+1], v207 offset:32768
    ds_read_b64_tr_b16 v[190:190+1], v207 offset:33792
    s_waitcnt lgkmcnt(6)
    v_mfma_f32_32x32x16_bf16 v[64:79], v[176:179], v[128:131], v[64:79]
    ds_read_b64_tr_b16 v[176:176+1], v204 offset:36864
    ds_read_b64_tr_b16 v[178:178+1], v204 offset:37888
    s_waitcnt lgkmcnt(6)
    v_mfma_f32_32x32x16_bf16 v[80:95], v[180:183], v[128:131], v[80:95]
    ds_read_b64_tr_b16 v[180:180+1], v205 offset:36864
    ds_read_b64_tr_b16 v[182:182+1], v205 offset:37888
    s_waitcnt lgkmcnt(6)
    v_mfma_f32_32x32x16_bf16 v[96:111], v[184:187], v[128:131], v[96:111]
    ds_read_b64_tr_b16 v[184:184+1], v206 offset:36864
    ds_read_b64_tr_b16 v[186:186+1], v206 offset:37888
    s_waitcnt lgkmcnt(6)
    v_mfma_f32_32x32x16_bf16 v[112:127], v[188:191], v[128:131], v[112:127]
    ds_read_b64_tr_b16 v[188:188+1], v207 offset:36864
    ds_read_b64_tr_b16 v[190:190+1], v207 offset:37888
    s_waitcnt lgkmcnt(6)
    v_mfma_f32_32x32x16_bf16 v[64:79], v[176:179], v[132:135], v[64:79]
    ds_read_b64_tr_b16 v[176:176+1], v204 offset:40960
    ds_read_b64_tr_b16 v[178:178+1], v204 offset:41984
    s_waitcnt lgkmcnt(6)
    v_mfma_f32_32x32x16_bf16 v[80:95], v[180:183], v[132:135], v[80:95]
    ds_read_b64_tr_b16 v[180:180+1], v205 offset:40960
    ds_read_b64_tr_b16 v[182:182+1], v205 offset:41984
    s_waitcnt lgkmcnt(6)
    v_mfma_f32_32x32x16_bf16 v[96:111], v[184:187], v[132:135], v[96:111]
    ds_read_b64_tr_b16 v[184:184+1], v206 offset:40960
    ds_read_b64_tr_b16 v[186:186+1], v206 offset:41984
    s_waitcnt lgkmcnt(6)
    v_mfma_f32_32x32x16_bf16 v[112:127], v[188:191], v[132:135], v[112:127]
    ds_read_b64_tr_b16 v[188:188+1], v207 offset:40960
    ds_read_b64_tr_b16 v[190:190+1], v207 offset:41984
    s_waitcnt lgkmcnt(6)
    v_mfma_f32_32x32x16_bf16 v[64:79], v[176:179], v[136:139], v[64:79]
    ds_read_b64_tr_b16 v[176:176+1], v204 offset:45056
    ds_read_b64_tr_b16 v[178:178+1], v204 offset:46080
    s_waitcnt lgkmcnt(6)
    v_mfma_f32_32x32x16_bf16 v[80:95], v[180:183], v[136:139], v[80:95]
    ds_read_b64_tr_b16 v[180:180+1], v205 offset:45056
    ds_read_b64_tr_b16 v[182:182+1], v205 offset:46080
    s_waitcnt lgkmcnt(6)
    v_mfma_f32_32x32x16_bf16 v[96:111], v[184:187], v[136:139], v[96:111]
    ds_read_b64_tr_b16 v[184:184+1], v206 offset:45056
    ds_read_b64_tr_b16 v[186:186+1], v206 offset:46080
    s_waitcnt lgkmcnt(6)
    v_mfma_f32_32x32x16_bf16 v[112:127], v[188:191], v[136:139], v[112:127]
    ds_read_b64_tr_b16 v[188:188+1], v207 offset:45056
    ds_read_b64_tr_b16 v[190:190+1], v207 offset:46080
    s_waitcnt lgkmcnt(6)
    v_mfma_f32_32x32x16_bf16 v[64:79], v[176:179], v[140:143], v[64:79]
    s_waitcnt lgkmcnt(4)
    v_mfma_f32_32x32x16_bf16 v[80:95], v[180:183], v[140:143], v[80:95]
    s_waitcnt lgkmcnt(2)
    v_mfma_f32_32x32x16_bf16 v[96:111], v[184:187], v[140:143], v[96:111]
    s_waitcnt lgkmcnt(0)
    v_mfma_f32_32x32x16_bf16 v[112:127], v[188:191], v[140:143], v[112:127]
    s_waitcnt vmcnt(16)
    s_barrier
    buffer_load_dwordx4 v[128:131], v208, s[20:23], 0 offen offset:512
    buffer_load_dwordx4 v[132:135], v208, s[20:23], 0 offen offset:544
    buffer_load_dwordx4 v[136:139], v208, s[20:23], 0 offen offset:576
    buffer_load_dwordx4 v[140:143], v208, s[20:23], 0 offen offset:608
    s_add_u32 m0, s44, 32768
    s_add_u32 s40, s45, 393216
    buffer_load_dwordx4 v221, s[32:35], s40 offen offset:0 lds
    s_add_u32 s40, s45, 396288
    buffer_load_dwordx4 v221, s[32:35], s40 offen offset:1024 lds
    s_add_u32 s40, s45, 399360
    buffer_load_dwordx4 v221, s[32:35], s40 offen offset:2048 lds
    s_add_u32 s40, s45, 402432
    buffer_load_dwordx4 v221, s[32:35], s40 offen offset:3072 lds
    s_waitcnt vmcnt(12)
    ds_read_b64_tr_b16 v[176:176+1], v204 offset:49152
    ds_read_b64_tr_b16 v[178:178+1], v204 offset:50176
    ds_read_b64_tr_b16 v[180:180+1], v205 offset:49152
    ds_read_b64_tr_b16 v[182:182+1], v205 offset:50176
    ds_read_b64_tr_b16 v[184:184+1], v206 offset:49152
    ds_read_b64_tr_b16 v[186:186+1], v206 offset:50176
    ds_read_b64_tr_b16 v[188:188+1], v207 offset:49152
    ds_read_b64_tr_b16 v[190:190+1], v207 offset:50176
    s_waitcnt lgkmcnt(6)
    v_mfma_f32_32x32x16_bf16 v[64:79], v[176:179], v[144:147], v[64:79]
    ds_read_b64_tr_b16 v[176:176+1], v204 offset:53248
    ds_read_b64_tr_b16 v[178:178+1], v204 offset:54272
    s_waitcnt lgkmcnt(6)
    v_mfma_f32_32x32x16_bf16 v[80:95], v[180:183], v[144:147], v[80:95]
    ds_read_b64_tr_b16 v[180:180+1], v205 offset:53248
    ds_read_b64_tr_b16 v[182:182+1], v205 offset:54272
    s_waitcnt lgkmcnt(6)
    v_mfma_f32_32x32x16_bf16 v[96:111], v[184:187], v[144:147], v[96:111]
    ds_read_b64_tr_b16 v[184:184+1], v206 offset:53248
    ds_read_b64_tr_b16 v[186:186+1], v206 offset:54272
    s_waitcnt lgkmcnt(6)
    v_mfma_f32_32x32x16_bf16 v[112:127], v[188:191], v[144:147], v[112:127]
    ds_read_b64_tr_b16 v[188:188+1], v207 offset:53248
    ds_read_b64_tr_b16 v[190:190+1], v207 offset:54272
    s_waitcnt lgkmcnt(6)
    v_mfma_f32_32x32x16_bf16 v[64:79], v[176:179], v[148:151], v[64:79]
    ds_read_b64_tr_b16 v[176:176+1], v204 offset:57344
    ds_read_b64_tr_b16 v[178:178+1], v204 offset:58368
    s_waitcnt lgkmcnt(6)
    v_mfma_f32_32x32x16_bf16 v[80:95], v[180:183], v[148:151], v[80:95]
    ds_read_b64_tr_b16 v[180:180+1], v205 offset:57344
    ds_read_b64_tr_b16 v[182:182+1], v205 offset:58368
    s_waitcnt lgkmcnt(6)
    v_mfma_f32_32x32x16_bf16 v[96:111], v[184:187], v[148:151], v[96:111]
    ds_read_b64_tr_b16 v[184:184+1], v206 offset:57344
    ds_read_b64_tr_b16 v[186:186+1], v206 offset:58368
    s_waitcnt lgkmcnt(6)
    v_mfma_f32_32x32x16_bf16 v[112:127], v[188:191], v[148:151], v[112:127]
    ds_read_b64_tr_b16 v[188:188+1], v207 offset:57344
    ds_read_b64_tr_b16 v[190:190+1], v207 offset:58368
    s_waitcnt lgkmcnt(6)
    v_mfma_f32_32x32x16_bf16 v[64:79], v[176:179], v[152:155], v[64:79]
    ds_read_b64_tr_b16 v[176:176+1], v204 offset:61440
    ds_read_b64_tr_b16 v[178:178+1], v204 offset:62464
    s_waitcnt lgkmcnt(6)
    v_mfma_f32_32x32x16_bf16 v[80:95], v[180:183], v[152:155], v[80:95]
    ds_read_b64_tr_b16 v[180:180+1], v205 offset:61440
    ds_read_b64_tr_b16 v[182:182+1], v205 offset:62464
    s_waitcnt lgkmcnt(6)
    v_mfma_f32_32x32x16_bf16 v[96:111], v[184:187], v[152:155], v[96:111]
    ds_read_b64_tr_b16 v[184:184+1], v206 offset:61440
    ds_read_b64_tr_b16 v[186:186+1], v206 offset:62464
    s_waitcnt lgkmcnt(6)
    v_mfma_f32_32x32x16_bf16 v[112:127], v[188:191], v[152:155], v[112:127]
    ds_read_b64_tr_b16 v[188:188+1], v207 offset:61440
    ds_read_b64_tr_b16 v[190:190+1], v207 offset:62464
    s_waitcnt lgkmcnt(6)
    v_mfma_f32_32x32x16_bf16 v[64:79], v[176:179], v[156:159], v[64:79]
    s_waitcnt lgkmcnt(4)
    v_mfma_f32_32x32x16_bf16 v[80:95], v[180:183], v[156:159], v[80:95]
    s_waitcnt lgkmcnt(2)
    v_mfma_f32_32x32x16_bf16 v[96:111], v[184:187], v[156:159], v[96:111]
    s_waitcnt lgkmcnt(0)
    v_mfma_f32_32x32x16_bf16 v[112:127], v[188:191], v[156:159], v[112:127]
    s_waitcnt vmcnt(16)
    s_barrier
    buffer_load_dwordx4 v[144:147], v208, s[20:23], 0 offen offset:640
    buffer_load_dwordx4 v[148:151], v208, s[20:23], 0 offen offset:672
    buffer_load_dwordx4 v[152:155], v208, s[20:23], 0 offen offset:704
    buffer_load_dwordx4 v[156:159], v208, s[20:23], 0 offen offset:736
    s_add_u32 m0, s44, 49152
    s_add_u32 s40, s45, 458752
    buffer_load_dwordx4 v221, s[32:35], s40 offen offset:0 lds
    s_add_u32 s40, s45, 461824
    buffer_load_dwordx4 v221, s[32:35], s40 offen offset:1024 lds
    s_add_u32 s40, s45, 464896
    buffer_load_dwordx4 v221, s[32:35], s40 offen offset:2048 lds
    s_add_u32 s40, s45, 467968
    buffer_load_dwordx4 v221, s[32:35], s40 offen offset:3072 lds
    s_waitcnt vmcnt(12)
    ds_read_b64_tr_b16 v[176:176+1], v204 offset:0
    ds_read_b64_tr_b16 v[178:178+1], v204 offset:1024
    ds_read_b64_tr_b16 v[180:180+1], v205 offset:0
    ds_read_b64_tr_b16 v[182:182+1], v205 offset:1024
    ds_read_b64_tr_b16 v[184:184+1], v206 offset:0
    ds_read_b64_tr_b16 v[186:186+1], v206 offset:1024
    ds_read_b64_tr_b16 v[188:188+1], v207 offset:0
    ds_read_b64_tr_b16 v[190:190+1], v207 offset:1024
    s_waitcnt lgkmcnt(6)
    v_mfma_f32_32x32x16_bf16 v[64:79], v[176:179], v[128:131], v[64:79]
    ds_read_b64_tr_b16 v[176:176+1], v204 offset:4096
    ds_read_b64_tr_b16 v[178:178+1], v204 offset:5120
    s_waitcnt lgkmcnt(6)
    v_mfma_f32_32x32x16_bf16 v[80:95], v[180:183], v[128:131], v[80:95]
    ds_read_b64_tr_b16 v[180:180+1], v205 offset:4096
    ds_read_b64_tr_b16 v[182:182+1], v205 offset:5120
    s_waitcnt lgkmcnt(6)
    v_mfma_f32_32x32x16_bf16 v[96:111], v[184:187], v[128:131], v[96:111]
    ds_read_b64_tr_b16 v[184:184+1], v206 offset:4096
    ds_read_b64_tr_b16 v[186:186+1], v206 offset:5120
    s_waitcnt lgkmcnt(6)
    v_mfma_f32_32x32x16_bf16 v[112:127], v[188:191], v[128:131], v[112:127]
    ds_read_b64_tr_b16 v[188:188+1], v207 offset:4096
    ds_read_b64_tr_b16 v[190:190+1], v207 offset:5120
    s_waitcnt lgkmcnt(6)
    v_mfma_f32_32x32x16_bf16 v[64:79], v[176:179], v[132:135], v[64:79]
    ds_read_b64_tr_b16 v[176:176+1], v204 offset:8192
    ds_read_b64_tr_b16 v[178:178+1], v204 offset:9216
    s_waitcnt lgkmcnt(6)
    v_mfma_f32_32x32x16_bf16 v[80:95], v[180:183], v[132:135], v[80:95]
    ds_read_b64_tr_b16 v[180:180+1], v205 offset:8192
    ds_read_b64_tr_b16 v[182:182+1], v205 offset:9216
    s_waitcnt lgkmcnt(6)
    v_mfma_f32_32x32x16_bf16 v[96:111], v[184:187], v[132:135], v[96:111]
    ds_read_b64_tr_b16 v[184:184+1], v206 offset:8192
    ds_read_b64_tr_b16 v[186:186+1], v206 offset:9216
    s_waitcnt lgkmcnt(6)
    v_mfma_f32_32x32x16_bf16 v[112:127], v[188:191], v[132:135], v[112:127]
    ds_read_b64_tr_b16 v[188:188+1], v207 offset:8192
    ds_read_b64_tr_b16 v[190:190+1], v207 offset:9216
    s_waitcnt lgkmcnt(6)
    v_mfma_f32_32x32x16_bf16 v[64:79], v[176:179], v[136:139], v[64:79]
    ds_read_b64_tr_b16 v[176:176+1], v204 offset:12288
    ds_read_b64_tr_b16 v[178:178+1], v204 offset:13312
    s_waitcnt lgkmcnt(6)
    v_mfma_f32_32x32x16_bf16 v[80:95], v[180:183], v[136:139], v[80:95]
    ds_read_b64_tr_b16 v[180:180+1], v205 offset:12288
    ds_read_b64_tr_b16 v[182:182+1], v205 offset:13312
    s_waitcnt lgkmcnt(6)
    v_mfma_f32_32x32x16_bf16 v[96:111], v[184:187], v[136:139], v[96:111]
    ds_read_b64_tr_b16 v[184:184+1], v206 offset:12288
    ds_read_b64_tr_b16 v[186:186+1], v206 offset:13312
    s_waitcnt lgkmcnt(6)
    v_mfma_f32_32x32x16_bf16 v[112:127], v[188:191], v[136:139], v[112:127]
    ds_read_b64_tr_b16 v[188:188+1], v207 offset:12288
    ds_read_b64_tr_b16 v[190:190+1], v207 offset:13312
    s_waitcnt lgkmcnt(6)
    v_mfma_f32_32x32x16_bf16 v[64:79], v[176:179], v[140:143], v[64:79]
    s_waitcnt lgkmcnt(4)
    v_mfma_f32_32x32x16_bf16 v[80:95], v[180:183], v[140:143], v[80:95]
    s_waitcnt lgkmcnt(2)
    v_mfma_f32_32x32x16_bf16 v[96:111], v[184:187], v[140:143], v[96:111]
    s_waitcnt lgkmcnt(0)
    v_mfma_f32_32x32x16_bf16 v[112:127], v[188:191], v[140:143], v[112:127]
    s_waitcnt vmcnt(16)
    s_barrier
    buffer_load_dwordx4 v[128:131], v208, s[20:23], 0 offen offset:768
    buffer_load_dwordx4 v[132:135], v208, s[20:23], 0 offen offset:800
    buffer_load_dwordx4 v[136:139], v208, s[20:23], 0 offen offset:832
    buffer_load_dwordx4 v[140:143], v208, s[20:23], 0 offen offset:864
    s_add_u32 m0, s44, 0
    s_add_u32 s40, s45, 524288
    buffer_load_dwordx4 v221, s[32:35], s40 offen offset:0 lds
    s_add_u32 s40, s45, 527360
    buffer_load_dwordx4 v221, s[32:35], s40 offen offset:1024 lds
    s_add_u32 s40, s45, 530432
    buffer_load_dwordx4 v221, s[32:35], s40 offen offset:2048 lds
    s_add_u32 s40, s45, 533504
    buffer_load_dwordx4 v221, s[32:35], s40 offen offset:3072 lds
    s_waitcnt vmcnt(12)
    ds_read_b64_tr_b16 v[176:176+1], v204 offset:16384
    ds_read_b64_tr_b16 v[178:178+1], v204 offset:17408
    ds_read_b64_tr_b16 v[180:180+1], v205 offset:16384
    ds_read_b64_tr_b16 v[182:182+1], v205 offset:17408
    ds_read_b64_tr_b16 v[184:184+1], v206 offset:16384
    ds_read_b64_tr_b16 v[186:186+1], v206 offset:17408
    ds_read_b64_tr_b16 v[188:188+1], v207 offset:16384
    ds_read_b64_tr_b16 v[190:190+1], v207 offset:17408
    s_waitcnt lgkmcnt(6)
    v_mfma_f32_32x32x16_bf16 v[64:79], v[176:179], v[144:147], v[64:79]
    ds_read_b64_tr_b16 v[176:176+1], v204 offset:20480
    ds_read_b64_tr_b16 v[178:178+1], v204 offset:21504
    s_waitcnt lgkmcnt(6)
    v_mfma_f32_32x32x16_bf16 v[80:95], v[180:183], v[144:147], v[80:95]
    ds_read_b64_tr_b16 v[180:180+1], v205 offset:20480
    ds_read_b64_tr_b16 v[182:182+1], v205 offset:21504
    s_waitcnt lgkmcnt(6)
    v_mfma_f32_32x32x16_bf16 v[96:111], v[184:187], v[144:147], v[96:111]
    ds_read_b64_tr_b16 v[184:184+1], v206 offset:20480
    ds_read_b64_tr_b16 v[186:186+1], v206 offset:21504
    s_waitcnt lgkmcnt(6)
    v_mfma_f32_32x32x16_bf16 v[112:127], v[188:191], v[144:147], v[112:127]
    ds_read_b64_tr_b16 v[188:188+1], v207 offset:20480
    ds_read_b64_tr_b16 v[190:190+1], v207 offset:21504
    s_waitcnt lgkmcnt(6)
    v_mfma_f32_32x32x16_bf16 v[64:79], v[176:179], v[148:151], v[64:79]
    ds_read_b64_tr_b16 v[176:176+1], v204 offset:24576
    ds_read_b64_tr_b16 v[178:178+1], v204 offset:25600
    s_waitcnt lgkmcnt(6)
    v_mfma_f32_32x32x16_bf16 v[80:95], v[180:183], v[148:151], v[80:95]
    ds_read_b64_tr_b16 v[180:180+1], v205 offset:24576
    ds_read_b64_tr_b16 v[182:182+1], v205 offset:25600
    s_waitcnt lgkmcnt(6)
    v_mfma_f32_32x32x16_bf16 v[96:111], v[184:187], v[148:151], v[96:111]
    ds_read_b64_tr_b16 v[184:184+1], v206 offset:24576
    ds_read_b64_tr_b16 v[186:186+1], v206 offset:25600
    s_waitcnt lgkmcnt(6)
    v_mfma_f32_32x32x16_bf16 v[112:127], v[188:191], v[148:151], v[112:127]
    ds_read_b64_tr_b16 v[188:188+1], v207 offset:24576
    ds_read_b64_tr_b16 v[190:190+1], v207 offset:25600
    s_waitcnt lgkmcnt(6)
    v_mfma_f32_32x32x16_bf16 v[64:79], v[176:179], v[152:155], v[64:79]
    ds_read_b64_tr_b16 v[176:176+1], v204 offset:28672
    ds_read_b64_tr_b16 v[178:178+1], v204 offset:29696
    s_waitcnt lgkmcnt(6)
    v_mfma_f32_32x32x16_bf16 v[80:95], v[180:183], v[152:155], v[80:95]
    ds_read_b64_tr_b16 v[180:180+1], v205 offset:28672
    ds_read_b64_tr_b16 v[182:182+1], v205 offset:29696
    s_waitcnt lgkmcnt(6)
    v_mfma_f32_32x32x16_bf16 v[96:111], v[184:187], v[152:155], v[96:111]
    ds_read_b64_tr_b16 v[184:184+1], v206 offset:28672
    ds_read_b64_tr_b16 v[186:186+1], v206 offset:29696
    s_waitcnt lgkmcnt(6)
    v_mfma_f32_32x32x16_bf16 v[112:127], v[188:191], v[152:155], v[112:127]
    ds_read_b64_tr_b16 v[188:188+1], v207 offset:28672
    ds_read_b64_tr_b16 v[190:190+1], v207 offset:29696
    s_waitcnt lgkmcnt(6)
    v_mfma_f32_32x32x16_bf16 v[64:79], v[176:179], v[156:159], v[64:79]
    s_waitcnt lgkmcnt(4)
    v_mfma_f32_32x32x16_bf16 v[80:95], v[180:183], v[156:159], v[80:95]
    s_waitcnt lgkmcnt(2)
    v_mfma_f32_32x32x16_bf16 v[96:111], v[184:187], v[156:159], v[96:111]
    s_waitcnt lgkmcnt(0)
    v_mfma_f32_32x32x16_bf16 v[112:127], v[188:191], v[156:159], v[112:127]
    s_waitcnt vmcnt(16)
    s_barrier
    buffer_load_dwordx4 v[144:147], v208, s[20:23], 0 offen offset:896
    buffer_load_dwordx4 v[148:151], v208, s[20:23], 0 offen offset:928
    buffer_load_dwordx4 v[152:155], v208, s[20:23], 0 offen offset:960
    buffer_load_dwordx4 v[156:159], v208, s[20:23], 0 offen offset:992
    s_add_u32 m0, s44, 16384
    s_add_u32 s40, s45, 589824
    buffer_load_dwordx4 v221, s[32:35], s40 offen offset:0 lds
    s_add_u32 s40, s45, 592896
    buffer_load_dwordx4 v221, s[32:35], s40 offen offset:1024 lds
    s_add_u32 s40, s45, 595968
    buffer_load_dwordx4 v221, s[32:35], s40 offen offset:2048 lds
    s_add_u32 s40, s45, 599040
    buffer_load_dwordx4 v221, s[32:35], s40 offen offset:3072 lds
    s_waitcnt vmcnt(12)
    ds_read_b64_tr_b16 v[176:176+1], v204 offset:32768
    ds_read_b64_tr_b16 v[178:178+1], v204 offset:33792
    ds_read_b64_tr_b16 v[180:180+1], v205 offset:32768
    ds_read_b64_tr_b16 v[182:182+1], v205 offset:33792
    ds_read_b64_tr_b16 v[184:184+1], v206 offset:32768
    ds_read_b64_tr_b16 v[186:186+1], v206 offset:33792
    ds_read_b64_tr_b16 v[188:188+1], v207 offset:32768
    ds_read_b64_tr_b16 v[190:190+1], v207 offset:33792
    s_waitcnt lgkmcnt(6)
    v_mfma_f32_32x32x16_bf16 v[64:79], v[176:179], v[128:131], v[64:79]
    ds_read_b64_tr_b16 v[176:176+1], v204 offset:36864
    ds_read_b64_tr_b16 v[178:178+1], v204 offset:37888
    s_waitcnt lgkmcnt(6)
    v_mfma_f32_32x32x16_bf16 v[80:95], v[180:183], v[128:131], v[80:95]
    ds_read_b64_tr_b16 v[180:180+1], v205 offset:36864
    ds_read_b64_tr_b16 v[182:182+1], v205 offset:37888
    s_waitcnt lgkmcnt(6)
    v_mfma_f32_32x32x16_bf16 v[96:111], v[184:187], v[128:131], v[96:111]
    ds_read_b64_tr_b16 v[184:184+1], v206 offset:36864
    ds_read_b64_tr_b16 v[186:186+1], v206 offset:37888
    s_waitcnt lgkmcnt(6)
    v_mfma_f32_32x32x16_bf16 v[112:127], v[188:191], v[128:131], v[112:127]
    ds_read_b64_tr_b16 v[188:188+1], v207 offset:36864
    ds_read_b64_tr_b16 v[190:190+1], v207 offset:37888
    s_waitcnt lgkmcnt(6)
    v_mfma_f32_32x32x16_bf16 v[64:79], v[176:179], v[132:135], v[64:79]
    ds_read_b64_tr_b16 v[176:176+1], v204 offset:40960
    ds_read_b64_tr_b16 v[178:178+1], v204 offset:41984
    s_waitcnt lgkmcnt(6)
    v_mfma_f32_32x32x16_bf16 v[80:95], v[180:183], v[132:135], v[80:95]
    ds_read_b64_tr_b16 v[180:180+1], v205 offset:40960
    ds_read_b64_tr_b16 v[182:182+1], v205 offset:41984
    s_waitcnt lgkmcnt(6)
    v_mfma_f32_32x32x16_bf16 v[96:111], v[184:187], v[132:135], v[96:111]
    ds_read_b64_tr_b16 v[184:184+1], v206 offset:40960
    ds_read_b64_tr_b16 v[186:186+1], v206 offset:41984
    s_waitcnt lgkmcnt(6)
    v_mfma_f32_32x32x16_bf16 v[112:127], v[188:191], v[132:135], v[112:127]
    ds_read_b64_tr_b16 v[188:188+1], v207 offset:40960
    ds_read_b64_tr_b16 v[190:190+1], v207 offset:41984
    s_waitcnt lgkmcnt(6)
    v_mfma_f32_32x32x16_bf16 v[64:79], v[176:179], v[136:139], v[64:79]
    ds_read_b64_tr_b16 v[176:176+1], v204 offset:45056
    ds_read_b64_tr_b16 v[178:178+1], v204 offset:46080
    s_waitcnt lgkmcnt(6)
    v_mfma_f32_32x32x16_bf16 v[80:95], v[180:183], v[136:139], v[80:95]
    ds_read_b64_tr_b16 v[180:180+1], v205 offset:45056
    ds_read_b64_tr_b16 v[182:182+1], v205 offset:46080
    s_waitcnt lgkmcnt(6)
    v_mfma_f32_32x32x16_bf16 v[96:111], v[184:187], v[136:139], v[96:111]
    ds_read_b64_tr_b16 v[184:184+1], v206 offset:45056
    ds_read_b64_tr_b16 v[186:186+1], v206 offset:46080
    s_waitcnt lgkmcnt(6)
    v_mfma_f32_32x32x16_bf16 v[112:127], v[188:191], v[136:139], v[112:127]
    ds_read_b64_tr_b16 v[188:188+1], v207 offset:45056
    ds_read_b64_tr_b16 v[190:190+1], v207 offset:46080
    s_waitcnt lgkmcnt(6)
    v_mfma_f32_32x32x16_bf16 v[64:79], v[176:179], v[140:143], v[64:79]
    s_waitcnt lgkmcnt(4)
    v_mfma_f32_32x32x16_bf16 v[80:95], v[180:183], v[140:143], v[80:95]
    s_waitcnt lgkmcnt(2)
    v_mfma_f32_32x32x16_bf16 v[96:111], v[184:187], v[140:143], v[96:111]
    s_waitcnt lgkmcnt(0)
    v_mfma_f32_32x32x16_bf16 v[112:127], v[188:191], v[140:143], v[112:127]
    s_waitcnt vmcnt(16)
    s_barrier
    buffer_load_dwordx4 v[128:131], v208, s[20:23], 0 offen offset:1024
    buffer_load_dwordx4 v[132:135], v208, s[20:23], 0 offen offset:1056
    buffer_load_dwordx4 v[136:139], v208, s[20:23], 0 offen offset:1088
    buffer_load_dwordx4 v[140:143], v208, s[20:23], 0 offen offset:1120
    s_add_u32 m0, s44, 32768
    s_add_u32 s40, s45, 655360
    buffer_load_dwordx4 v221, s[32:35], s40 offen offset:0 lds
    s_add_u32 s40, s45, 658432
    buffer_load_dwordx4 v221, s[32:35], s40 offen offset:1024 lds
    s_add_u32 s40, s45, 661504
    buffer_load_dwordx4 v221, s[32:35], s40 offen offset:2048 lds
    s_add_u32 s40, s45, 664576
    buffer_load_dwordx4 v221, s[32:35], s40 offen offset:3072 lds
    s_waitcnt vmcnt(12)
    ds_read_b64_tr_b16 v[176:176+1], v204 offset:49152
    ds_read_b64_tr_b16 v[178:178+1], v204 offset:50176
    ds_read_b64_tr_b16 v[180:180+1], v205 offset:49152
    ds_read_b64_tr_b16 v[182:182+1], v205 offset:50176
    ds_read_b64_tr_b16 v[184:184+1], v206 offset:49152
    ds_read_b64_tr_b16 v[186:186+1], v206 offset:50176
    ds_read_b64_tr_b16 v[188:188+1], v207 offset:49152
    ds_read_b64_tr_b16 v[190:190+1], v207 offset:50176
    s_waitcnt lgkmcnt(6)
    v_mfma_f32_32x32x16_bf16 v[64:79], v[176:179], v[144:147], v[64:79]
    ds_read_b64_tr_b16 v[176:176+1], v204 offset:53248
    ds_read_b64_tr_b16 v[178:178+1], v204 offset:54272
    s_waitcnt lgkmcnt(6)
    v_mfma_f32_32x32x16_bf16 v[80:95], v[180:183], v[144:147], v[80:95]
    ds_read_b64_tr_b16 v[180:180+1], v205 offset:53248
    ds_read_b64_tr_b16 v[182:182+1], v205 offset:54272
    s_waitcnt lgkmcnt(6)
    v_mfma_f32_32x32x16_bf16 v[96:111], v[184:187], v[144:147], v[96:111]
    ds_read_b64_tr_b16 v[184:184+1], v206 offset:53248
    ds_read_b64_tr_b16 v[186:186+1], v206 offset:54272
    s_waitcnt lgkmcnt(6)
    v_mfma_f32_32x32x16_bf16 v[112:127], v[188:191], v[144:147], v[112:127]
    ds_read_b64_tr_b16 v[188:188+1], v207 offset:53248
    ds_read_b64_tr_b16 v[190:190+1], v207 offset:54272
    s_waitcnt lgkmcnt(6)
    v_mfma_f32_32x32x16_bf16 v[64:79], v[176:179], v[148:151], v[64:79]
    ds_read_b64_tr_b16 v[176:176+1], v204 offset:57344
    ds_read_b64_tr_b16 v[178:178+1], v204 offset:58368
    s_waitcnt lgkmcnt(6)
    v_mfma_f32_32x32x16_bf16 v[80:95], v[180:183], v[148:151], v[80:95]
    ds_read_b64_tr_b16 v[180:180+1], v205 offset:57344
    ds_read_b64_tr_b16 v[182:182+1], v205 offset:58368
    s_waitcnt lgkmcnt(6)
    v_mfma_f32_32x32x16_bf16 v[96:111], v[184:187], v[148:151], v[96:111]
    ds_read_b64_tr_b16 v[184:184+1], v206 offset:57344
    ds_read_b64_tr_b16 v[186:186+1], v206 offset:58368
    s_waitcnt lgkmcnt(6)
    v_mfma_f32_32x32x16_bf16 v[112:127], v[188:191], v[148:151], v[112:127]
    ds_read_b64_tr_b16 v[188:188+1], v207 offset:57344
    ds_read_b64_tr_b16 v[190:190+1], v207 offset:58368
    s_waitcnt lgkmcnt(6)
    v_mfma_f32_32x32x16_bf16 v[64:79], v[176:179], v[152:155], v[64:79]
    ds_read_b64_tr_b16 v[176:176+1], v204 offset:61440
    ds_read_b64_tr_b16 v[178:178+1], v204 offset:62464
    s_waitcnt lgkmcnt(6)
    v_mfma_f32_32x32x16_bf16 v[80:95], v[180:183], v[152:155], v[80:95]
    ds_read_b64_tr_b16 v[180:180+1], v205 offset:61440
    ds_read_b64_tr_b16 v[182:182+1], v205 offset:62464
    s_waitcnt lgkmcnt(6)
    v_mfma_f32_32x32x16_bf16 v[96:111], v[184:187], v[152:155], v[96:111]
    ds_read_b64_tr_b16 v[184:184+1], v206 offset:61440
    ds_read_b64_tr_b16 v[186:186+1], v206 offset:62464
    s_waitcnt lgkmcnt(6)
    v_mfma_f32_32x32x16_bf16 v[112:127], v[188:191], v[152:155], v[112:127]
    ds_read_b64_tr_b16 v[188:188+1], v207 offset:61440
    ds_read_b64_tr_b16 v[190:190+1], v207 offset:62464
    s_waitcnt lgkmcnt(6)
    v_mfma_f32_32x32x16_bf16 v[64:79], v[176:179], v[156:159], v[64:79]
    s_waitcnt lgkmcnt(4)
    v_mfma_f32_32x32x16_bf16 v[80:95], v[180:183], v[156:159], v[80:95]
    s_waitcnt lgkmcnt(2)
    v_mfma_f32_32x32x16_bf16 v[96:111], v[184:187], v[156:159], v[96:111]
    s_waitcnt lgkmcnt(0)
    v_mfma_f32_32x32x16_bf16 v[112:127], v[188:191], v[156:159], v[112:127]
    s_waitcnt vmcnt(16)
    s_barrier
    buffer_load_dwordx4 v[144:147], v208, s[20:23], 0 offen offset:1152
    buffer_load_dwordx4 v[148:151], v208, s[20:23], 0 offen offset:1184
    buffer_load_dwordx4 v[152:155], v208, s[20:23], 0 offen offset:1216
    buffer_load_dwordx4 v[156:159], v208, s[20:23], 0 offen offset:1248
    s_add_u32 m0, s44, 49152
    s_add_u32 s40, s45, 720896
    buffer_load_dwordx4 v221, s[32:35], s40 offen offset:0 lds
    s_add_u32 s40, s45, 723968
    buffer_load_dwordx4 v221, s[32:35], s40 offen offset:1024 lds
    s_add_u32 s40, s45, 727040
    buffer_load_dwordx4 v221, s[32:35], s40 offen offset:2048 lds
    s_add_u32 s40, s45, 730112
    buffer_load_dwordx4 v221, s[32:35], s40 offen offset:3072 lds
    s_waitcnt vmcnt(12)
    ds_read_b64_tr_b16 v[176:176+1], v204 offset:0
    ds_read_b64_tr_b16 v[178:178+1], v204 offset:1024
    ds_read_b64_tr_b16 v[180:180+1], v205 offset:0
    ds_read_b64_tr_b16 v[182:182+1], v205 offset:1024
    ds_read_b64_tr_b16 v[184:184+1], v206 offset:0
    ds_read_b64_tr_b16 v[186:186+1], v206 offset:1024
    ds_read_b64_tr_b16 v[188:188+1], v207 offset:0
    ds_read_b64_tr_b16 v[190:190+1], v207 offset:1024
    s_waitcnt lgkmcnt(6)
    v_mfma_f32_32x32x16_bf16 v[64:79], v[176:179], v[128:131], v[64:79]
    ds_read_b64_tr_b16 v[176:176+1], v204 offset:4096
    ds_read_b64_tr_b16 v[178:178+1], v204 offset:5120
    s_waitcnt lgkmcnt(6)
    v_mfma_f32_32x32x16_bf16 v[80:95], v[180:183], v[128:131], v[80:95]
    ds_read_b64_tr_b16 v[180:180+1], v205 offset:4096
    ds_read_b64_tr_b16 v[182:182+1], v205 offset:5120
    s_waitcnt lgkmcnt(6)
    v_mfma_f32_32x32x16_bf16 v[96:111], v[184:187], v[128:131], v[96:111]
    ds_read_b64_tr_b16 v[184:184+1], v206 offset:4096
    ds_read_b64_tr_b16 v[186:186+1], v206 offset:5120
    s_waitcnt lgkmcnt(6)
    v_mfma_f32_32x32x16_bf16 v[112:127], v[188:191], v[128:131], v[112:127]
    ds_read_b64_tr_b16 v[188:188+1], v207 offset:4096
    ds_read_b64_tr_b16 v[190:190+1], v207 offset:5120
    s_waitcnt lgkmcnt(6)
    v_mfma_f32_32x32x16_bf16 v[64:79], v[176:179], v[132:135], v[64:79]
    ds_read_b64_tr_b16 v[176:176+1], v204 offset:8192
    ds_read_b64_tr_b16 v[178:178+1], v204 offset:9216
    s_waitcnt lgkmcnt(6)
    v_mfma_f32_32x32x16_bf16 v[80:95], v[180:183], v[132:135], v[80:95]
    ds_read_b64_tr_b16 v[180:180+1], v205 offset:8192
    ds_read_b64_tr_b16 v[182:182+1], v205 offset:9216
    s_waitcnt lgkmcnt(6)
    v_mfma_f32_32x32x16_bf16 v[96:111], v[184:187], v[132:135], v[96:111]
    ds_read_b64_tr_b16 v[184:184+1], v206 offset:8192
    ds_read_b64_tr_b16 v[186:186+1], v206 offset:9216
    s_waitcnt lgkmcnt(6)
    v_mfma_f32_32x32x16_bf16 v[112:127], v[188:191], v[132:135], v[112:127]
    ds_read_b64_tr_b16 v[188:188+1], v207 offset:8192
    ds_read_b64_tr_b16 v[190:190+1], v207 offset:9216
    s_waitcnt lgkmcnt(6)
    v_mfma_f32_32x32x16_bf16 v[64:79], v[176:179], v[136:139], v[64:79]
    ds_read_b64_tr_b16 v[176:176+1], v204 offset:12288
    ds_read_b64_tr_b16 v[178:178+1], v204 offset:13312
    s_waitcnt lgkmcnt(6)
    v_mfma_f32_32x32x16_bf16 v[80:95], v[180:183], v[136:139], v[80:95]
    ds_read_b64_tr_b16 v[180:180+1], v205 offset:12288
    ds_read_b64_tr_b16 v[182:182+1], v205 offset:13312
    s_waitcnt lgkmcnt(6)
    v_mfma_f32_32x32x16_bf16 v[96:111], v[184:187], v[136:139], v[96:111]
    ds_read_b64_tr_b16 v[184:184+1], v206 offset:12288
    ds_read_b64_tr_b16 v[186:186+1], v206 offset:13312
    s_waitcnt lgkmcnt(6)
    v_mfma_f32_32x32x16_bf16 v[112:127], v[188:191], v[136:139], v[112:127]
    ds_read_b64_tr_b16 v[188:188+1], v207 offset:12288
    ds_read_b64_tr_b16 v[190:190+1], v207 offset:13312
    s_waitcnt lgkmcnt(6)
    v_mfma_f32_32x32x16_bf16 v[64:79], v[176:179], v[140:143], v[64:79]
    s_waitcnt lgkmcnt(4)
    v_mfma_f32_32x32x16_bf16 v[80:95], v[180:183], v[140:143], v[80:95]
    s_waitcnt lgkmcnt(2)
    v_mfma_f32_32x32x16_bf16 v[96:111], v[184:187], v[140:143], v[96:111]
    s_waitcnt lgkmcnt(0)
    v_mfma_f32_32x32x16_bf16 v[112:127], v[188:191], v[140:143], v[112:127]
    s_waitcnt vmcnt(16)
    s_barrier
    buffer_load_dwordx4 v[128:131], v208, s[20:23], 0 offen offset:1280
    buffer_load_dwordx4 v[132:135], v208, s[20:23], 0 offen offset:1312
    buffer_load_dwordx4 v[136:139], v208, s[20:23], 0 offen offset:1344
    buffer_load_dwordx4 v[140:143], v208, s[20:23], 0 offen offset:1376
    s_add_u32 m0, s44, 0
    s_add_u32 s40, s45, 786432
    buffer_load_dwordx4 v221, s[32:35], s40 offen offset:0 lds
    s_add_u32 s40, s45, 789504
    buffer_load_dwordx4 v221, s[32:35], s40 offen offset:1024 lds
    s_add_u32 s40, s45, 792576
    buffer_load_dwordx4 v221, s[32:35], s40 offen offset:2048 lds
    s_add_u32 s40, s45, 795648
    buffer_load_dwordx4 v221, s[32:35], s40 offen offset:3072 lds
    s_waitcnt vmcnt(12)
    ds_read_b64_tr_b16 v[176:176+1], v204 offset:16384
    ds_read_b64_tr_b16 v[178:178+1], v204 offset:17408
    ds_read_b64_tr_b16 v[180:180+1], v205 offset:16384
    ds_read_b64_tr_b16 v[182:182+1], v205 offset:17408
    ds_read_b64_tr_b16 v[184:184+1], v206 offset:16384
    ds_read_b64_tr_b16 v[186:186+1], v206 offset:17408
    ds_read_b64_tr_b16 v[188:188+1], v207 offset:16384
    ds_read_b64_tr_b16 v[190:190+1], v207 offset:17408
    s_waitcnt lgkmcnt(6)
    v_mfma_f32_32x32x16_bf16 v[64:79], v[176:179], v[144:147], v[64:79]
    ds_read_b64_tr_b16 v[176:176+1], v204 offset:20480
    ds_read_b64_tr_b16 v[178:178+1], v204 offset:21504
    s_waitcnt lgkmcnt(6)
    v_mfma_f32_32x32x16_bf16 v[80:95], v[180:183], v[144:147], v[80:95]
    ds_read_b64_tr_b16 v[180:180+1], v205 offset:20480
    ds_read_b64_tr_b16 v[182:182+1], v205 offset:21504
    s_waitcnt lgkmcnt(6)
    v_mfma_f32_32x32x16_bf16 v[96:111], v[184:187], v[144:147], v[96:111]
    ds_read_b64_tr_b16 v[184:184+1], v206 offset:20480
    ds_read_b64_tr_b16 v[186:186+1], v206 offset:21504
    s_waitcnt lgkmcnt(6)
    v_mfma_f32_32x32x16_bf16 v[112:127], v[188:191], v[144:147], v[112:127]
    ds_read_b64_tr_b16 v[188:188+1], v207 offset:20480
    ds_read_b64_tr_b16 v[190:190+1], v207 offset:21504
    s_waitcnt lgkmcnt(6)
    v_mfma_f32_32x32x16_bf16 v[64:79], v[176:179], v[148:151], v[64:79]
    ds_read_b64_tr_b16 v[176:176+1], v204 offset:24576
    ds_read_b64_tr_b16 v[178:178+1], v204 offset:25600
    s_waitcnt lgkmcnt(6)
    v_mfma_f32_32x32x16_bf16 v[80:95], v[180:183], v[148:151], v[80:95]
    ds_read_b64_tr_b16 v[180:180+1], v205 offset:24576
    ds_read_b64_tr_b16 v[182:182+1], v205 offset:25600
    s_waitcnt lgkmcnt(6)
    v_mfma_f32_32x32x16_bf16 v[96:111], v[184:187], v[148:151], v[96:111]
    ds_read_b64_tr_b16 v[184:184+1], v206 offset:24576
    ds_read_b64_tr_b16 v[186:186+1], v206 offset:25600
    s_waitcnt lgkmcnt(6)
    v_mfma_f32_32x32x16_bf16 v[112:127], v[188:191], v[148:151], v[112:127]
    ds_read_b64_tr_b16 v[188:188+1], v207 offset:24576
    ds_read_b64_tr_b16 v[190:190+1], v207 offset:25600
    s_waitcnt lgkmcnt(6)
    v_mfma_f32_32x32x16_bf16 v[64:79], v[176:179], v[152:155], v[64:79]
    ds_read_b64_tr_b16 v[176:176+1], v204 offset:28672
    ds_read_b64_tr_b16 v[178:178+1], v204 offset:29696
    s_waitcnt lgkmcnt(6)
    v_mfma_f32_32x32x16_bf16 v[80:95], v[180:183], v[152:155], v[80:95]
    ds_read_b64_tr_b16 v[180:180+1], v205 offset:28672
    ds_read_b64_tr_b16 v[182:182+1], v205 offset:29696
    s_waitcnt lgkmcnt(6)
    v_mfma_f32_32x32x16_bf16 v[96:111], v[184:187], v[152:155], v[96:111]
    ds_read_b64_tr_b16 v[184:184+1], v206 offset:28672
    ds_read_b64_tr_b16 v[186:186+1], v206 offset:29696
    s_waitcnt lgkmcnt(6)
    v_mfma_f32_32x32x16_bf16 v[112:127], v[188:191], v[152:155], v[112:127]
    ds_read_b64_tr_b16 v[188:188+1], v207 offset:28672
    ds_read_b64_tr_b16 v[190:190+1], v207 offset:29696
    s_waitcnt lgkmcnt(6)
    v_mfma_f32_32x32x16_bf16 v[64:79], v[176:179], v[156:159], v[64:79]
    s_waitcnt lgkmcnt(4)
    v_mfma_f32_32x32x16_bf16 v[80:95], v[180:183], v[156:159], v[80:95]
    s_waitcnt lgkmcnt(2)
    v_mfma_f32_32x32x16_bf16 v[96:111], v[184:187], v[156:159], v[96:111]
    s_waitcnt lgkmcnt(0)
    v_mfma_f32_32x32x16_bf16 v[112:127], v[188:191], v[156:159], v[112:127]
    s_waitcnt vmcnt(16)
    s_barrier
    buffer_load_dwordx4 v[144:147], v208, s[20:23], 0 offen offset:1408
    buffer_load_dwordx4 v[148:151], v208, s[20:23], 0 offen offset:1440
    buffer_load_dwordx4 v[152:155], v208, s[20:23], 0 offen offset:1472
    buffer_load_dwordx4 v[156:159], v208, s[20:23], 0 offen offset:1504
    s_add_u32 m0, s44, 16384
    s_add_u32 s40, s45, 851968
    buffer_load_dwordx4 v221, s[32:35], s40 offen offset:0 lds
    s_add_u32 s40, s45, 855040
    buffer_load_dwordx4 v221, s[32:35], s40 offen offset:1024 lds
    s_add_u32 s40, s45, 858112
    buffer_load_dwordx4 v221, s[32:35], s40 offen offset:2048 lds
    s_add_u32 s40, s45, 861184
    buffer_load_dwordx4 v221, s[32:35], s40 offen offset:3072 lds
    s_waitcnt vmcnt(12)
    ds_read_b64_tr_b16 v[176:176+1], v204 offset:32768
    ds_read_b64_tr_b16 v[178:178+1], v204 offset:33792
    ds_read_b64_tr_b16 v[180:180+1], v205 offset:32768
    ds_read_b64_tr_b16 v[182:182+1], v205 offset:33792
    ds_read_b64_tr_b16 v[184:184+1], v206 offset:32768
    ds_read_b64_tr_b16 v[186:186+1], v206 offset:33792
    ds_read_b64_tr_b16 v[188:188+1], v207 offset:32768
    ds_read_b64_tr_b16 v[190:190+1], v207 offset:33792
    s_waitcnt lgkmcnt(6)
    v_mfma_f32_32x32x16_bf16 v[64:79], v[176:179], v[128:131], v[64:79]
    ds_read_b64_tr_b16 v[176:176+1], v204 offset:36864
    ds_read_b64_tr_b16 v[178:178+1], v204 offset:37888
    s_waitcnt lgkmcnt(6)
    v_mfma_f32_32x32x16_bf16 v[80:95], v[180:183], v[128:131], v[80:95]
    ds_read_b64_tr_b16 v[180:180+1], v205 offset:36864
    ds_read_b64_tr_b16 v[182:182+1], v205 offset:37888
    s_waitcnt lgkmcnt(6)
    v_mfma_f32_32x32x16_bf16 v[96:111], v[184:187], v[128:131], v[96:111]
    ds_read_b64_tr_b16 v[184:184+1], v206 offset:36864
    ds_read_b64_tr_b16 v[186:186+1], v206 offset:37888
    s_waitcnt lgkmcnt(6)
    v_mfma_f32_32x32x16_bf16 v[112:127], v[188:191], v[128:131], v[112:127]
    ds_read_b64_tr_b16 v[188:188+1], v207 offset:36864
    ds_read_b64_tr_b16 v[190:190+1], v207 offset:37888
    s_waitcnt lgkmcnt(6)
    v_mfma_f32_32x32x16_bf16 v[64:79], v[176:179], v[132:135], v[64:79]
    ds_read_b64_tr_b16 v[176:176+1], v204 offset:40960
    ds_read_b64_tr_b16 v[178:178+1], v204 offset:41984
    s_waitcnt lgkmcnt(6)
    v_mfma_f32_32x32x16_bf16 v[80:95], v[180:183], v[132:135], v[80:95]
    ds_read_b64_tr_b16 v[180:180+1], v205 offset:40960
    ds_read_b64_tr_b16 v[182:182+1], v205 offset:41984
    s_waitcnt lgkmcnt(6)
    v_mfma_f32_32x32x16_bf16 v[96:111], v[184:187], v[132:135], v[96:111]
    ds_read_b64_tr_b16 v[184:184+1], v206 offset:40960
    ds_read_b64_tr_b16 v[186:186+1], v206 offset:41984
    s_waitcnt lgkmcnt(6)
    v_mfma_f32_32x32x16_bf16 v[112:127], v[188:191], v[132:135], v[112:127]
    ds_read_b64_tr_b16 v[188:188+1], v207 offset:40960
    ds_read_b64_tr_b16 v[190:190+1], v207 offset:41984
    s_waitcnt lgkmcnt(6)
    v_mfma_f32_32x32x16_bf16 v[64:79], v[176:179], v[136:139], v[64:79]
    ds_read_b64_tr_b16 v[176:176+1], v204 offset:45056
    ds_read_b64_tr_b16 v[178:178+1], v204 offset:46080
    s_waitcnt lgkmcnt(6)
    v_mfma_f32_32x32x16_bf16 v[80:95], v[180:183], v[136:139], v[80:95]
    ds_read_b64_tr_b16 v[180:180+1], v205 offset:45056
    ds_read_b64_tr_b16 v[182:182+1], v205 offset:46080
    s_waitcnt lgkmcnt(6)
    v_mfma_f32_32x32x16_bf16 v[96:111], v[184:187], v[136:139], v[96:111]
    ds_read_b64_tr_b16 v[184:184+1], v206 offset:45056
    ds_read_b64_tr_b16 v[186:186+1], v206 offset:46080
    s_waitcnt lgkmcnt(6)
    v_mfma_f32_32x32x16_bf16 v[112:127], v[188:191], v[136:139], v[112:127]
    ds_read_b64_tr_b16 v[188:188+1], v207 offset:45056
    ds_read_b64_tr_b16 v[190:190+1], v207 offset:46080
    s_waitcnt lgkmcnt(6)
    v_mfma_f32_32x32x16_bf16 v[64:79], v[176:179], v[140:143], v[64:79]
    s_waitcnt lgkmcnt(4)
    v_mfma_f32_32x32x16_bf16 v[80:95], v[180:183], v[140:143], v[80:95]
    s_waitcnt lgkmcnt(2)
    v_mfma_f32_32x32x16_bf16 v[96:111], v[184:187], v[140:143], v[96:111]
    s_waitcnt lgkmcnt(0)
    v_mfma_f32_32x32x16_bf16 v[112:127], v[188:191], v[140:143], v[112:127]
    s_waitcnt vmcnt(16)
    s_barrier
    buffer_load_dwordx4 v[128:131], v208, s[20:23], 0 offen offset:1536
    buffer_load_dwordx4 v[132:135], v208, s[20:23], 0 offen offset:1568
    buffer_load_dwordx4 v[136:139], v208, s[20:23], 0 offen offset:1600
    buffer_load_dwordx4 v[140:143], v208, s[20:23], 0 offen offset:1632
    s_add_u32 m0, s44, 32768
    s_add_u32 s40, s45, 917504
    buffer_load_dwordx4 v221, s[32:35], s40 offen offset:0 lds
    s_add_u32 s40, s45, 920576
    buffer_load_dwordx4 v221, s[32:35], s40 offen offset:1024 lds
    s_add_u32 s40, s45, 923648
    buffer_load_dwordx4 v221, s[32:35], s40 offen offset:2048 lds
    s_add_u32 s40, s45, 926720
    buffer_load_dwordx4 v221, s[32:35], s40 offen offset:3072 lds
    s_waitcnt vmcnt(12)
    ds_read_b64_tr_b16 v[176:176+1], v204 offset:49152
    ds_read_b64_tr_b16 v[178:178+1], v204 offset:50176
    ds_read_b64_tr_b16 v[180:180+1], v205 offset:49152
    ds_read_b64_tr_b16 v[182:182+1], v205 offset:50176
    ds_read_b64_tr_b16 v[184:184+1], v206 offset:49152
    ds_read_b64_tr_b16 v[186:186+1], v206 offset:50176
    ds_read_b64_tr_b16 v[188:188+1], v207 offset:49152
    ds_read_b64_tr_b16 v[190:190+1], v207 offset:50176
    s_waitcnt lgkmcnt(6)
    v_mfma_f32_32x32x16_bf16 v[64:79], v[176:179], v[144:147], v[64:79]
    ds_read_b64_tr_b16 v[176:176+1], v204 offset:53248
    ds_read_b64_tr_b16 v[178:178+1], v204 offset:54272
    s_waitcnt lgkmcnt(6)
    v_mfma_f32_32x32x16_bf16 v[80:95], v[180:183], v[144:147], v[80:95]
    ds_read_b64_tr_b16 v[180:180+1], v205 offset:53248
    ds_read_b64_tr_b16 v[182:182+1], v205 offset:54272
    s_waitcnt lgkmcnt(6)
    v_mfma_f32_32x32x16_bf16 v[96:111], v[184:187], v[144:147], v[96:111]
    ds_read_b64_tr_b16 v[184:184+1], v206 offset:53248
    ds_read_b64_tr_b16 v[186:186+1], v206 offset:54272
    s_waitcnt lgkmcnt(6)
    v_mfma_f32_32x32x16_bf16 v[112:127], v[188:191], v[144:147], v[112:127]
    ds_read_b64_tr_b16 v[188:188+1], v207 offset:53248
    ds_read_b64_tr_b16 v[190:190+1], v207 offset:54272
    s_waitcnt lgkmcnt(6)
    v_mfma_f32_32x32x16_bf16 v[64:79], v[176:179], v[148:151], v[64:79]
    ds_read_b64_tr_b16 v[176:176+1], v204 offset:57344
    ds_read_b64_tr_b16 v[178:178+1], v204 offset:58368
    s_waitcnt lgkmcnt(6)
    v_mfma_f32_32x32x16_bf16 v[80:95], v[180:183], v[148:151], v[80:95]
    ds_read_b64_tr_b16 v[180:180+1], v205 offset:57344
    ds_read_b64_tr_b16 v[182:182+1], v205 offset:58368
    s_waitcnt lgkmcnt(6)
    v_mfma_f32_32x32x16_bf16 v[96:111], v[184:187], v[148:151], v[96:111]
    ds_read_b64_tr_b16 v[184:184+1], v206 offset:57344
    ds_read_b64_tr_b16 v[186:186+1], v206 offset:58368
    s_waitcnt lgkmcnt(6)
    v_mfma_f32_32x32x16_bf16 v[112:127], v[188:191], v[148:151], v[112:127]
    ds_read_b64_tr_b16 v[188:188+1], v207 offset:57344
    ds_read_b64_tr_b16 v[190:190+1], v207 offset:58368
    s_waitcnt lgkmcnt(6)
    v_mfma_f32_32x32x16_bf16 v[64:79], v[176:179], v[152:155], v[64:79]
    ds_read_b64_tr_b16 v[176:176+1], v204 offset:61440
    ds_read_b64_tr_b16 v[178:178+1], v204 offset:62464
    s_waitcnt lgkmcnt(6)
    v_mfma_f32_32x32x16_bf16 v[80:95], v[180:183], v[152:155], v[80:95]
    ds_read_b64_tr_b16 v[180:180+1], v205 offset:61440
    ds_read_b64_tr_b16 v[182:182+1], v205 offset:62464
    s_waitcnt lgkmcnt(6)
    v_mfma_f32_32x32x16_bf16 v[96:111], v[184:187], v[152:155], v[96:111]
    ds_read_b64_tr_b16 v[184:184+1], v206 offset:61440
    ds_read_b64_tr_b16 v[186:186+1], v206 offset:62464
    s_waitcnt lgkmcnt(6)
    v_mfma_f32_32x32x16_bf16 v[112:127], v[188:191], v[152:155], v[112:127]
    ds_read_b64_tr_b16 v[188:188+1], v207 offset:61440
    ds_read_b64_tr_b16 v[190:190+1], v207 offset:62464
    s_waitcnt lgkmcnt(6)
    v_mfma_f32_32x32x16_bf16 v[64:79], v[176:179], v[156:159], v[64:79]
    s_waitcnt lgkmcnt(4)
    v_mfma_f32_32x32x16_bf16 v[80:95], v[180:183], v[156:159], v[80:95]
    s_waitcnt lgkmcnt(2)
    v_mfma_f32_32x32x16_bf16 v[96:111], v[184:187], v[156:159], v[96:111]
    s_waitcnt lgkmcnt(0)
    v_mfma_f32_32x32x16_bf16 v[112:127], v[188:191], v[156:159], v[112:127]
    s_waitcnt vmcnt(16)
    s_barrier
    buffer_load_dwordx4 v[144:147], v208, s[20:23], 0 offen offset:1664
    buffer_load_dwordx4 v[148:151], v208, s[20:23], 0 offen offset:1696
    buffer_load_dwordx4 v[152:155], v208, s[20:23], 0 offen offset:1728
    buffer_load_dwordx4 v[156:159], v208, s[20:23], 0 offen offset:1760
    s_add_u32 m0, s44, 49152
    s_add_u32 s40, s45, 983040
    buffer_load_dwordx4 v221, s[32:35], s40 offen offset:0 lds
    s_add_u32 s40, s45, 986112
    buffer_load_dwordx4 v221, s[32:35], s40 offen offset:1024 lds
    s_add_u32 s40, s45, 989184
    buffer_load_dwordx4 v221, s[32:35], s40 offen offset:2048 lds
    s_add_u32 s40, s45, 992256
    buffer_load_dwordx4 v221, s[32:35], s40 offen offset:3072 lds
    s_waitcnt vmcnt(12)
    ds_read_b64_tr_b16 v[176:176+1], v204 offset:0
    ds_read_b64_tr_b16 v[178:178+1], v204 offset:1024
    ds_read_b64_tr_b16 v[180:180+1], v205 offset:0
    ds_read_b64_tr_b16 v[182:182+1], v205 offset:1024
    ds_read_b64_tr_b16 v[184:184+1], v206 offset:0
    ds_read_b64_tr_b16 v[186:186+1], v206 offset:1024
    ds_read_b64_tr_b16 v[188:188+1], v207 offset:0
    ds_read_b64_tr_b16 v[190:190+1], v207 offset:1024
    s_waitcnt lgkmcnt(6)
    v_mfma_f32_32x32x16_bf16 v[64:79], v[176:179], v[128:131], v[64:79]
    ds_read_b64_tr_b16 v[176:176+1], v204 offset:4096
    ds_read_b64_tr_b16 v[178:178+1], v204 offset:5120
    s_waitcnt lgkmcnt(6)
    v_mfma_f32_32x32x16_bf16 v[80:95], v[180:183], v[128:131], v[80:95]
    ds_read_b64_tr_b16 v[180:180+1], v205 offset:4096
    ds_read_b64_tr_b16 v[182:182+1], v205 offset:5120
    s_waitcnt lgkmcnt(6)
    v_mfma_f32_32x32x16_bf16 v[96:111], v[184:187], v[128:131], v[96:111]
    ds_read_b64_tr_b16 v[184:184+1], v206 offset:4096
    ds_read_b64_tr_b16 v[186:186+1], v206 offset:5120
    s_waitcnt lgkmcnt(6)
    v_mfma_f32_32x32x16_bf16 v[112:127], v[188:191], v[128:131], v[112:127]
    ds_read_b64_tr_b16 v[188:188+1], v207 offset:4096
    ds_read_b64_tr_b16 v[190:190+1], v207 offset:5120
    s_waitcnt lgkmcnt(6)
    v_mfma_f32_32x32x16_bf16 v[64:79], v[176:179], v[132:135], v[64:79]
    ds_read_b64_tr_b16 v[176:176+1], v204 offset:8192
    ds_read_b64_tr_b16 v[178:178+1], v204 offset:9216
    s_waitcnt lgkmcnt(6)
    v_mfma_f32_32x32x16_bf16 v[80:95], v[180:183], v[132:135], v[80:95]
    ds_read_b64_tr_b16 v[180:180+1], v205 offset:8192
    ds_read_b64_tr_b16 v[182:182+1], v205 offset:9216
    s_waitcnt lgkmcnt(6)
    v_mfma_f32_32x32x16_bf16 v[96:111], v[184:187], v[132:135], v[96:111]
    ds_read_b64_tr_b16 v[184:184+1], v206 offset:8192
    ds_read_b64_tr_b16 v[186:186+1], v206 offset:9216
    s_waitcnt lgkmcnt(6)
    v_mfma_f32_32x32x16_bf16 v[112:127], v[188:191], v[132:135], v[112:127]
    ds_read_b64_tr_b16 v[188:188+1], v207 offset:8192
    ds_read_b64_tr_b16 v[190:190+1], v207 offset:9216
    s_waitcnt lgkmcnt(6)
    v_mfma_f32_32x32x16_bf16 v[64:79], v[176:179], v[136:139], v[64:79]
    ds_read_b64_tr_b16 v[176:176+1], v204 offset:12288
    ds_read_b64_tr_b16 v[178:178+1], v204 offset:13312
    s_waitcnt lgkmcnt(6)
    v_mfma_f32_32x32x16_bf16 v[80:95], v[180:183], v[136:139], v[80:95]
    ds_read_b64_tr_b16 v[180:180+1], v205 offset:12288
    ds_read_b64_tr_b16 v[182:182+1], v205 offset:13312
    s_waitcnt lgkmcnt(6)
    v_mfma_f32_32x32x16_bf16 v[96:111], v[184:187], v[136:139], v[96:111]
    ds_read_b64_tr_b16 v[184:184+1], v206 offset:12288
    ds_read_b64_tr_b16 v[186:186+1], v206 offset:13312
    s_waitcnt lgkmcnt(6)
    v_mfma_f32_32x32x16_bf16 v[112:127], v[188:191], v[136:139], v[112:127]
    ds_read_b64_tr_b16 v[188:188+1], v207 offset:12288
    ds_read_b64_tr_b16 v[190:190+1], v207 offset:13312
    s_waitcnt lgkmcnt(6)
    v_mfma_f32_32x32x16_bf16 v[64:79], v[176:179], v[140:143], v[64:79]
    s_waitcnt lgkmcnt(4)
    v_mfma_f32_32x32x16_bf16 v[80:95], v[180:183], v[140:143], v[80:95]
    s_waitcnt lgkmcnt(2)
    v_mfma_f32_32x32x16_bf16 v[96:111], v[184:187], v[140:143], v[96:111]
    s_waitcnt lgkmcnt(0)
    v_mfma_f32_32x32x16_bf16 v[112:127], v[188:191], v[140:143], v[112:127]
    s_waitcnt vmcnt(16)
    s_barrier
    buffer_load_dwordx4 v[128:131], v208, s[20:23], 0 offen offset:1792
    buffer_load_dwordx4 v[132:135], v208, s[20:23], 0 offen offset:1824
    buffer_load_dwordx4 v[136:139], v208, s[20:23], 0 offen offset:1856
    buffer_load_dwordx4 v[140:143], v208, s[20:23], 0 offen offset:1888
    s_waitcnt vmcnt(8)
    ds_read_b64_tr_b16 v[176:176+1], v204 offset:16384
    ds_read_b64_tr_b16 v[178:178+1], v204 offset:17408
    ds_read_b64_tr_b16 v[180:180+1], v205 offset:16384
    ds_read_b64_tr_b16 v[182:182+1], v205 offset:17408
    ds_read_b64_tr_b16 v[184:184+1], v206 offset:16384
    ds_read_b64_tr_b16 v[186:186+1], v206 offset:17408
    ds_read_b64_tr_b16 v[188:188+1], v207 offset:16384
    ds_read_b64_tr_b16 v[190:190+1], v207 offset:17408
    s_waitcnt lgkmcnt(6)
    v_mfma_f32_32x32x16_bf16 v[64:79], v[176:179], v[144:147], v[64:79]
    ds_read_b64_tr_b16 v[176:176+1], v204 offset:20480
    ds_read_b64_tr_b16 v[178:178+1], v204 offset:21504
    s_waitcnt lgkmcnt(6)
    v_mfma_f32_32x32x16_bf16 v[80:95], v[180:183], v[144:147], v[80:95]
    ds_read_b64_tr_b16 v[180:180+1], v205 offset:20480
    ds_read_b64_tr_b16 v[182:182+1], v205 offset:21504
    s_waitcnt lgkmcnt(6)
    v_mfma_f32_32x32x16_bf16 v[96:111], v[184:187], v[144:147], v[96:111]
    ds_read_b64_tr_b16 v[184:184+1], v206 offset:20480
    ds_read_b64_tr_b16 v[186:186+1], v206 offset:21504
    s_waitcnt lgkmcnt(6)
    v_mfma_f32_32x32x16_bf16 v[112:127], v[188:191], v[144:147], v[112:127]
    ds_read_b64_tr_b16 v[188:188+1], v207 offset:20480
    ds_read_b64_tr_b16 v[190:190+1], v207 offset:21504
    s_waitcnt lgkmcnt(6)
    v_mfma_f32_32x32x16_bf16 v[64:79], v[176:179], v[148:151], v[64:79]
    ds_read_b64_tr_b16 v[176:176+1], v204 offset:24576
    ds_read_b64_tr_b16 v[178:178+1], v204 offset:25600
    s_waitcnt lgkmcnt(6)
    v_mfma_f32_32x32x16_bf16 v[80:95], v[180:183], v[148:151], v[80:95]
    ds_read_b64_tr_b16 v[180:180+1], v205 offset:24576
    ds_read_b64_tr_b16 v[182:182+1], v205 offset:25600
    s_waitcnt lgkmcnt(6)
    v_mfma_f32_32x32x16_bf16 v[96:111], v[184:187], v[148:151], v[96:111]
    ds_read_b64_tr_b16 v[184:184+1], v206 offset:24576
    ds_read_b64_tr_b16 v[186:186+1], v206 offset:25600
    s_waitcnt lgkmcnt(6)
    v_mfma_f32_32x32x16_bf16 v[112:127], v[188:191], v[148:151], v[112:127]
    ds_read_b64_tr_b16 v[188:188+1], v207 offset:24576
    ds_read_b64_tr_b16 v[190:190+1], v207 offset:25600
    s_waitcnt lgkmcnt(6)
    v_mfma_f32_32x32x16_bf16 v[64:79], v[176:179], v[152:155], v[64:79]
    ds_read_b64_tr_b16 v[176:176+1], v204 offset:28672
    ds_read_b64_tr_b16 v[178:178+1], v204 offset:29696
    s_waitcnt lgkmcnt(6)
    v_mfma_f32_32x32x16_bf16 v[80:95], v[180:183], v[152:155], v[80:95]
    ds_read_b64_tr_b16 v[180:180+1], v205 offset:28672
    ds_read_b64_tr_b16 v[182:182+1], v205 offset:29696
    s_waitcnt lgkmcnt(6)
    v_mfma_f32_32x32x16_bf16 v[96:111], v[184:187], v[152:155], v[96:111]
    ds_read_b64_tr_b16 v[184:184+1], v206 offset:28672
    ds_read_b64_tr_b16 v[186:186+1], v206 offset:29696
    s_waitcnt lgkmcnt(6)
    v_mfma_f32_32x32x16_bf16 v[112:127], v[188:191], v[152:155], v[112:127]
    ds_read_b64_tr_b16 v[188:188+1], v207 offset:28672
    ds_read_b64_tr_b16 v[190:190+1], v207 offset:29696
    s_waitcnt lgkmcnt(6)
    v_mfma_f32_32x32x16_bf16 v[64:79], v[176:179], v[156:159], v[64:79]
    s_waitcnt lgkmcnt(4)
    v_mfma_f32_32x32x16_bf16 v[80:95], v[180:183], v[156:159], v[80:95]
    s_waitcnt lgkmcnt(2)
    v_mfma_f32_32x32x16_bf16 v[96:111], v[184:187], v[156:159], v[96:111]
    s_waitcnt lgkmcnt(0)
    v_mfma_f32_32x32x16_bf16 v[112:127], v[188:191], v[156:159], v[112:127]
    s_waitcnt vmcnt(12)
    s_barrier
    buffer_load_dwordx4 v[144:147], v208, s[20:23], 0 offen offset:1920
    buffer_load_dwordx4 v[148:151], v208, s[20:23], 0 offen offset:1952
    buffer_load_dwordx4 v[152:155], v208, s[20:23], 0 offen offset:1984
    buffer_load_dwordx4 v[156:159], v208, s[20:23], 0 offen offset:2016
    s_waitcnt vmcnt(4)
    ds_read_b64_tr_b16 v[176:176+1], v204 offset:32768
    ds_read_b64_tr_b16 v[178:178+1], v204 offset:33792
    ds_read_b64_tr_b16 v[180:180+1], v205 offset:32768
    ds_read_b64_tr_b16 v[182:182+1], v205 offset:33792
    ds_read_b64_tr_b16 v[184:184+1], v206 offset:32768
    ds_read_b64_tr_b16 v[186:186+1], v206 offset:33792
    ds_read_b64_tr_b16 v[188:188+1], v207 offset:32768
    ds_read_b64_tr_b16 v[190:190+1], v207 offset:33792
    s_waitcnt lgkmcnt(6)
    v_mfma_f32_32x32x16_bf16 v[64:79], v[176:179], v[128:131], v[64:79]
    ds_read_b64_tr_b16 v[176:176+1], v204 offset:36864
    ds_read_b64_tr_b16 v[178:178+1], v204 offset:37888
    s_waitcnt lgkmcnt(6)
    v_mfma_f32_32x32x16_bf16 v[80:95], v[180:183], v[128:131], v[80:95]
    ds_read_b64_tr_b16 v[180:180+1], v205 offset:36864
    ds_read_b64_tr_b16 v[182:182+1], v205 offset:37888
    s_waitcnt lgkmcnt(6)
    v_mfma_f32_32x32x16_bf16 v[96:111], v[184:187], v[128:131], v[96:111]
    ds_read_b64_tr_b16 v[184:184+1], v206 offset:36864
    ds_read_b64_tr_b16 v[186:186+1], v206 offset:37888
    s_waitcnt lgkmcnt(6)
    v_mfma_f32_32x32x16_bf16 v[112:127], v[188:191], v[128:131], v[112:127]
    ds_read_b64_tr_b16 v[188:188+1], v207 offset:36864
    ds_read_b64_tr_b16 v[190:190+1], v207 offset:37888
    s_waitcnt lgkmcnt(6)
    v_mfma_f32_32x32x16_bf16 v[64:79], v[176:179], v[132:135], v[64:79]
    ds_read_b64_tr_b16 v[176:176+1], v204 offset:40960
    ds_read_b64_tr_b16 v[178:178+1], v204 offset:41984
    s_waitcnt lgkmcnt(6)
    v_mfma_f32_32x32x16_bf16 v[80:95], v[180:183], v[132:135], v[80:95]
    ds_read_b64_tr_b16 v[180:180+1], v205 offset:40960
    ds_read_b64_tr_b16 v[182:182+1], v205 offset:41984
    s_waitcnt lgkmcnt(6)
    v_mfma_f32_32x32x16_bf16 v[96:111], v[184:187], v[132:135], v[96:111]
    ds_read_b64_tr_b16 v[184:184+1], v206 offset:40960
    ds_read_b64_tr_b16 v[186:186+1], v206 offset:41984
    s_waitcnt lgkmcnt(6)
    v_mfma_f32_32x32x16_bf16 v[112:127], v[188:191], v[132:135], v[112:127]
    ds_read_b64_tr_b16 v[188:188+1], v207 offset:40960
    ds_read_b64_tr_b16 v[190:190+1], v207 offset:41984
    s_waitcnt lgkmcnt(6)
    v_mfma_f32_32x32x16_bf16 v[64:79], v[176:179], v[136:139], v[64:79]
    ds_read_b64_tr_b16 v[176:176+1], v204 offset:45056
    ds_read_b64_tr_b16 v[178:178+1], v204 offset:46080
    s_waitcnt lgkmcnt(6)
    v_mfma_f32_32x32x16_bf16 v[80:95], v[180:183], v[136:139], v[80:95]
    ds_read_b64_tr_b16 v[180:180+1], v205 offset:45056
    ds_read_b64_tr_b16 v[182:182+1], v205 offset:46080
    s_waitcnt lgkmcnt(6)
    v_mfma_f32_32x32x16_bf16 v[96:111], v[184:187], v[136:139], v[96:111]
    ds_read_b64_tr_b16 v[184:184+1], v206 offset:45056
    ds_read_b64_tr_b16 v[186:186+1], v206 offset:46080
    s_waitcnt lgkmcnt(6)
    v_mfma_f32_32x32x16_bf16 v[112:127], v[188:191], v[136:139], v[112:127]
    ds_read_b64_tr_b16 v[188:188+1], v207 offset:45056
    ds_read_b64_tr_b16 v[190:190+1], v207 offset:46080
    s_waitcnt lgkmcnt(6)
    v_mfma_f32_32x32x16_bf16 v[64:79], v[176:179], v[140:143], v[64:79]
    s_waitcnt lgkmcnt(4)
    v_mfma_f32_32x32x16_bf16 v[80:95], v[180:183], v[140:143], v[80:95]
    s_waitcnt lgkmcnt(2)
    v_mfma_f32_32x32x16_bf16 v[96:111], v[184:187], v[140:143], v[96:111]
    s_waitcnt lgkmcnt(0)
    v_mfma_f32_32x32x16_bf16 v[112:127], v[188:191], v[140:143], v[112:127]
    s_waitcnt vmcnt(8)
    s_barrier
    s_waitcnt vmcnt(0)
    ds_read_b64_tr_b16 v[176:176+1], v204 offset:49152
    ds_read_b64_tr_b16 v[178:178+1], v204 offset:50176
    ds_read_b64_tr_b16 v[180:180+1], v205 offset:49152
    ds_read_b64_tr_b16 v[182:182+1], v205 offset:50176
    ds_read_b64_tr_b16 v[184:184+1], v206 offset:49152
    ds_read_b64_tr_b16 v[186:186+1], v206 offset:50176
    ds_read_b64_tr_b16 v[188:188+1], v207 offset:49152
    ds_read_b64_tr_b16 v[190:190+1], v207 offset:50176
    s_waitcnt lgkmcnt(6)
    v_mfma_f32_32x32x16_bf16 v[64:79], v[176:179], v[144:147], v[64:79]
    ds_read_b64_tr_b16 v[176:176+1], v204 offset:53248
    ds_read_b64_tr_b16 v[178:178+1], v204 offset:54272
    s_waitcnt lgkmcnt(6)
    v_mfma_f32_32x32x16_bf16 v[80:95], v[180:183], v[144:147], v[80:95]
    ds_read_b64_tr_b16 v[180:180+1], v205 offset:53248
    ds_read_b64_tr_b16 v[182:182+1], v205 offset:54272
    s_waitcnt lgkmcnt(6)
    v_mfma_f32_32x32x16_bf16 v[96:111], v[184:187], v[144:147], v[96:111]
    ds_read_b64_tr_b16 v[184:184+1], v206 offset:53248
    ds_read_b64_tr_b16 v[186:186+1], v206 offset:54272
    s_waitcnt lgkmcnt(6)
    v_mfma_f32_32x32x16_bf16 v[112:127], v[188:191], v[144:147], v[112:127]
    ds_read_b64_tr_b16 v[188:188+1], v207 offset:53248
    ds_read_b64_tr_b16 v[190:190+1], v207 offset:54272
    s_waitcnt lgkmcnt(6)
    v_mfma_f32_32x32x16_bf16 v[64:79], v[176:179], v[148:151], v[64:79]
    ds_read_b64_tr_b16 v[176:176+1], v204 offset:57344
    ds_read_b64_tr_b16 v[178:178+1], v204 offset:58368
    s_waitcnt lgkmcnt(6)
    v_mfma_f32_32x32x16_bf16 v[80:95], v[180:183], v[148:151], v[80:95]
    ds_read_b64_tr_b16 v[180:180+1], v205 offset:57344
    ds_read_b64_tr_b16 v[182:182+1], v205 offset:58368
    s_waitcnt lgkmcnt(6)
    v_mfma_f32_32x32x16_bf16 v[96:111], v[184:187], v[148:151], v[96:111]
    ds_read_b64_tr_b16 v[184:184+1], v206 offset:57344
    ds_read_b64_tr_b16 v[186:186+1], v206 offset:58368
    s_waitcnt lgkmcnt(6)
    v_mfma_f32_32x32x16_bf16 v[112:127], v[188:191], v[148:151], v[112:127]
    ds_read_b64_tr_b16 v[188:188+1], v207 offset:57344
    ds_read_b64_tr_b16 v[190:190+1], v207 offset:58368
    s_waitcnt lgkmcnt(6)
    v_mfma_f32_32x32x16_bf16 v[64:79], v[176:179], v[152:155], v[64:79]
    ds_read_b64_tr_b16 v[176:176+1], v204 offset:61440
    ds_read_b64_tr_b16 v[178:178+1], v204 offset:62464
    s_waitcnt lgkmcnt(6)
    v_mfma_f32_32x32x16_bf16 v[80:95], v[180:183], v[152:155], v[80:95]
    ds_read_b64_tr_b16 v[180:180+1], v205 offset:61440
    ds_read_b64_tr_b16 v[182:182+1], v205 offset:62464
    s_waitcnt lgkmcnt(6)
    v_mfma_f32_32x32x16_bf16 v[96:111], v[184:187], v[152:155], v[96:111]
    ds_read_b64_tr_b16 v[184:184+1], v206 offset:61440
    ds_read_b64_tr_b16 v[186:186+1], v206 offset:62464
    s_waitcnt lgkmcnt(6)
    v_mfma_f32_32x32x16_bf16 v[112:127], v[188:191], v[152:155], v[112:127]
    ds_read_b64_tr_b16 v[188:188+1], v207 offset:61440
    ds_read_b64_tr_b16 v[190:190+1], v207 offset:62464
    s_waitcnt lgkmcnt(6)
    v_mfma_f32_32x32x16_bf16 v[64:79], v[176:179], v[156:159], v[64:79]
    s_waitcnt lgkmcnt(4)
    v_mfma_f32_32x32x16_bf16 v[80:95], v[180:183], v[156:159], v[80:95]
    s_waitcnt lgkmcnt(2)
    v_mfma_f32_32x32x16_bf16 v[96:111], v[184:187], v[156:159], v[96:111]
    s_waitcnt lgkmcnt(0)
    v_mfma_f32_32x32x16_bf16 v[112:127], v[188:191], v[156:159], v[112:127]
    s_nop 7
    s_nop 4
    buffer_store_dwordx4 v[64:67], v214, s[36:39], 0 offen offset:0
    buffer_store_dwordx4 v[68:71], v214, s[36:39], 0 offen offset:32
    buffer_store_dwordx4 v[72:75], v214, s[36:39], 0 offen offset:64
    buffer_store_dwordx4 v[76:79], v214, s[36:39], 0 offen offset:96
    buffer_store_dwordx4 v[80:83], v214, s[36:39], 0 offen offset:128
    buffer_store_dwordx4 v[84:87], v214, s[36:39], 0 offen offset:160
    buffer_store_dwordx4 v[88:91], v214, s[36:39], 0 offen offset:192
    buffer_store_dwordx4 v[92:95], v214, s[36:39], 0 offen offset:224
    buffer_store_dwordx4 v[96:99], v214, s[36:39], 0 offen offset:256
    buffer_store_dwordx4 v[100:103], v214, s[36:39], 0 offen offset:288
    buffer_store_dwordx4 v[104:107], v214, s[36:39], 0 offen offset:320
    buffer_store_dwordx4 v[108:111], v214, s[36:39], 0 offen offset:352
    buffer_store_dwordx4 v[112:115], v214, s[36:39], 0 offen offset:384
    buffer_store_dwordx4 v[116:119], v214, s[36:39], 0 offen offset:416
    buffer_store_dwordx4 v[120:123], v214, s[36:39], 0 offen offset:448
    buffer_store_dwordx4 v[124:127], v214, s[36:39], 0 offen offset:480
K2_exit:
    s_endpgm
K2_producer:
    v_and_b32 v20, 63, v0
    v_lshrrev_b32 v21, 4, v20
    v_and_b32 v22, 15, v20
    v_add_u32 v23, 0, v21
    v_xor_b32 v23, v23, v22
    v_lshlrev_b32 v23, 4, v23
    v_lshl_add_u32 v10, v21, 8, v23
    v_add_u32 v23, 4, v21
    v_xor_b32 v23, v23, v22
    v_lshlrev_b32 v23, 4, v23
    v_lshl_add_u32 v11, v21, 8, v23
    v_add_u32 v23, 8, v21
    v_xor_b32 v23, v23, v22
    v_lshlrev_b32 v23, 4, v23
    v_lshl_add_u32 v12, v21, 8, v23
    v_add_u32 v23, 12, v21
    v_xor_b32 v23, v23, v22
    v_lshlrev_b32 v23, 4, v23
    v_lshl_add_u32 v13, v21, 8, v23
    v_lshlrev_b32 v23, 2, v21
    v_xor_b32 v23, v23, v22
    v_lshlrev_b32 v23, 4, v23
    v_lshl_add_u32 v14, v21, 8, v23
    v_mul_u32_u24 v24, 1024, v21
    v_add_u32 v15, v24, v23
    s_lshl_b32 s44, s6, 12
    s_mul_i32 s45, s6, 16384
    s_add_u32 m0, s44, 0
    s_add_u32 s40, s45, 0
    buffer_load_dwordx4 v15, s[32:35], s40 offen offset:0 lds
    s_add_u32 s40, s45, 3072
    buffer_load_dwordx4 v15, s[32:35], s40 offen offset:1024 lds
    s_add_u32 s40, s45, 6144
    buffer_load_dwordx4 v15, s[32:35], s40 offen offset:2048 lds
    s_add_u32 s40, s45, 9216
    buffer_load_dwordx4 v15, s[32:35], s40 offen offset:3072 lds
    s_add_u32 m0, s44, 16384
    s_add_u32 s40, s45, 65536
    buffer_load_dwordx4 v15, s[32:35], s40 offen offset:0 lds
    s_add_u32 s40, s45, 68608
    buffer_load_dwordx4 v15, s[32:35], s40 offen offset:1024 lds
    s_add_u32 s40, s45, 71680
    buffer_load_dwordx4 v15, s[32:35], s40 offen offset:2048 lds
    s_add_u32 s40, s45, 74752
    buffer_load_dwordx4 v15, s[32:35], s40 offen offset:3072 lds
    s_add_u32 m0, s44, 32768
    s_add_u32 s40, s45, 131072
    buffer_load_dwordx4 v15, s[32:35], s40 offen offset:0 lds
    s_add_u32 s40, s45, 134144
    buffer_load_dwordx4 v15, s[32:35], s40 offen offset:1024 lds
    s_add_u32 s40, s45, 137216
    buffer_load_dwordx4 v15, s[32:35], s40 offen offset:2048 lds
    s_add_u32 s40, s45, 140288
    buffer_load_dwordx4 v15, s[32:35], s40 offen offset:3072 lds
    s_waitcnt vmcnt(8)
    s_barrier
    s_add_u32 m0, s44, 49152
    s_add_u32 s40, s45, 196608
    buffer_load_dwordx4 v15, s[32:35], s40 offen offset:0 lds
    s_add_u32 s40, s45, 199680
    buffer_load_dwordx4 v15, s[32:35], s40 offen offset:1024 lds
    s_add_u32 s40, s45, 202752
    buffer_load_dwordx4 v15, s[32:35], s40 offen offset:2048 lds
    s_add_u32 s40, s45, 205824
    buffer_load_dwordx4 v15, s[32:35], s40 offen offset:3072 lds
    s_waitcnt vmcnt(8)
    s_barrier
    s_add_u32 m0, s44, 0
    s_add_u32 s40, s45, 262144
    buffer_load_dwordx4 v15, s[32:35], s40 offen offset:0 lds
    s_add_u32 s40, s45, 265216
    buffer_load_dwordx4 v15, s[32:35], s40 offen offset:1024 lds
    s_add_u32 s40, s45, 268288
    buffer_load_dwordx4 v15, s[32:35], s40 offen offset:2048 lds
    s_add_u32 s40, s45, 271360
    buffer_load_dwordx4 v15, s[32:35], s40 offen offset:3072 lds
    s_waitcnt vmcnt(8)
    s_barrier
    s_add_u32 m0, s44, 16384
    s_add_u32 s40, s45, 327680
    buffer_load_dwordx4 v15, s[32:35], s40 offen offset:0 lds
    s_add_u32 s40, s45, 330752
    buffer_load_dwordx4 v15, s[32:35], s40 offen offset:1024 lds
    s_add_u32 s40, s45, 333824
    buffer_load_dwordx4 v15, s[32:35], s40 offen offset:2048 lds
    s_add_u32 s40, s45, 336896
    buffer_load_dwordx4 v15, s[32:35], s40 offen offset:3072 lds
    s_waitcnt vmcnt(8)
    s_barrier
    s_add_u32 m0, s44, 32768
    s_add_u32 s40, s45, 393216
    buffer_load_dwordx4 v15, s[32:35], s40 offen offset:0 lds
    s_add_u32 s40, s45, 396288
    buffer_load_dwordx4 v15, s[32:35], s40 offen offset:1024 lds
    s_add_u32 s40, s45, 399360
    buffer_load_dwordx4 v15, s[32:35], s40 offen offset:2048 lds
    s_add_u32 s40, s45, 402432
    buffer_load_dwordx4 v15, s[32:35], s40 offen offset:3072 lds
    s_waitcnt vmcnt(8)
    s_barrier
    s_add_u32 m0, s44, 49152
    s_add_u32 s40, s45, 458752
    buffer_load_dwordx4 v15, s[32:35], s40 offen offset:0 lds
    s_add_u32 s40, s45, 461824
    buffer_load_dwordx4 v15, s[32:35], s40 offen offset:1024 lds
    s_add_u32 s40, s45, 464896
    buffer_load_dwordx4 v15, s[32:35], s40 offen offset:2048 lds
    s_add_u32 s40, s45, 467968
    buffer_load_dwordx4 v15, s[32:35], s40 offen offset:3072 lds
    s_waitcnt vmcnt(8)
    s_barrier
    s_add_u32 m0, s44, 0
    s_add_u32 s40, s45, 524288
    buffer_load_dwordx4 v15, s[32:35], s40 offen offset:0 lds
    s_add_u32 s40, s45, 527360
    buffer_load_dwordx4 v15, s[32:35], s40 offen offset:1024 lds
    s_add_u32 s40, s45, 530432
    buffer_load_dwordx4 v15, s[32:35], s40 offen offset:2048 lds
    s_add_u32 s40, s45, 533504
    buffer_load_dwordx4 v15, s[32:35], s40 offen offset:3072 lds
    s_waitcnt vmcnt(8)
    s_barrier
    s_add_u32 m0, s44, 16384
    s_add_u32 s40, s45, 589824
    buffer_load_dwordx4 v15, s[32:35], s40 offen offset:0 lds
    s_add_u32 s40, s45, 592896
    buffer_load_dwordx4 v15, s[32:35], s40 offen offset:1024 lds
    s_add_u32 s40, s45, 595968
    buffer_load_dwordx4 v15, s[32:35], s40 offen offset:2048 lds
    s_add_u32 s40, s45, 599040
    buffer_load_dwordx4 v15, s[32:35], s40 offen offset:3072 lds
    s_waitcnt vmcnt(8)
    s_barrier
    s_add_u32 m0, s44, 32768
    s_add_u32 s40, s45, 655360
    buffer_load_dwordx4 v15, s[32:35], s40 offen offset:0 lds
    s_add_u32 s40, s45, 658432
    buffer_load_dwordx4 v15, s[32:35], s40 offen offset:1024 lds
    s_add_u32 s40, s45, 661504
    buffer_load_dwordx4 v15, s[32:35], s40 offen offset:2048 lds
    s_add_u32 s40, s45, 664576
    buffer_load_dwordx4 v15, s[32:35], s40 offen offset:3072 lds
    s_waitcnt vmcnt(8)
    s_barrier
    s_add_u32 m0, s44, 49152
    s_add_u32 s40, s45, 720896
    buffer_load_dwordx4 v15, s[32:35], s40 offen offset:0 lds
    s_add_u32 s40, s45, 723968
    buffer_load_dwordx4 v15, s[32:35], s40 offen offset:1024 lds
    s_add_u32 s40, s45, 727040
    buffer_load_dwordx4 v15, s[32:35], s40 offen offset:2048 lds
    s_add_u32 s40, s45, 730112
    buffer_load_dwordx4 v15, s[32:35], s40 offen offset:3072 lds
    s_waitcnt vmcnt(8)
    s_barrier
    s_add_u32 m0, s44, 0
    s_add_u32 s40, s45, 786432
    buffer_load_dwordx4 v15, s[32:35], s40 offen offset:0 lds
    s_add_u32 s40, s45, 789504
    buffer_load_dwordx4 v15, s[32:35], s40 offen offset:1024 lds
    s_add_u32 s40, s45, 792576
    buffer_load_dwordx4 v15, s[32:35], s40 offen offset:2048 lds
    s_add_u32 s40, s45, 795648
    buffer_load_dwordx4 v15, s[32:35], s40 offen offset:3072 lds
    s_waitcnt vmcnt(8)
    s_barrier
    s_add_u32 m0, s44, 16384
    s_add_u32 s40, s45, 851968
    buffer_load_dwordx4 v15, s[32:35], s40 offen offset:0 lds
    s_add_u32 s40, s45, 855040
    buffer_load_dwordx4 v15, s[32:35], s40 offen offset:1024 lds
    s_add_u32 s40, s45, 858112
    buffer_load_dwordx4 v15, s[32:35], s40 offen offset:2048 lds
    s_add_u32 s40, s45, 861184
    buffer_load_dwordx4 v15, s[32:35], s40 offen offset:3072 lds
    s_waitcnt vmcnt(8)
    s_barrier
    s_add_u32 m0, s44, 32768
    s_add_u32 s40, s45, 917504
    buffer_load_dwordx4 v15, s[32:35], s40 offen offset:0 lds
    s_add_u32 s40, s45, 920576
    buffer_load_dwordx4 v15, s[32:35], s40 offen offset:1024 lds
    s_add_u32 s40, s45, 923648
    buffer_load_dwordx4 v15, s[32:35], s40 offen offset:2048 lds
    s_add_u32 s40, s45, 926720
    buffer_load_dwordx4 v15, s[32:35], s40 offen offset:3072 lds
    s_waitcnt vmcnt(8)
    s_barrier
    s_add_u32 m0, s44, 49152
    s_add_u32 s40, s45, 983040
    buffer_load_dwordx4 v15, s[32:35], s40 offen offset:0 lds
    s_add_u32 s40, s45, 986112
    buffer_load_dwordx4 v15, s[32:35], s40 offen offset:1024 lds
    s_add_u32 s40, s45, 989184
    buffer_load_dwordx4 v15, s[32:35], s40 offen offset:2048 lds
    s_add_u32 s40, s45, 992256
    buffer_load_dwordx4 v15, s[32:35], s40 offen offset:3072 lds
    s_waitcnt vmcnt(8)
    s_barrier
    s_waitcnt vmcnt(4)
    s_barrier
    s_waitcnt vmcnt(0)
    s_barrier
    s_endpgm
.globl reduce_kernel
.p2align 8
.type reduce_kernel,@function
reduce_kernel:
    s_cmp_ge_u32 s2, 768
    s_cbranch_scc1 K3_exit
    s_load_dwordx2 s[16:17], s[0:1], 96
    s_load_dwordx2 s[18:19], s[0:1], 80
    s_waitcnt lgkmcnt(0)
    s_add_u32 s16, s16, 16777216
    s_addc_u32 s17, s17, 0
    s_mov_b32 s20, s16
    s_and_b32 s21, s17, 0xffff
    s_mov_b32 s22, 12582912
    s_mov_b32 s23, 0x20000
    s_mov_b32 s24, s18
    s_and_b32 s25, s19, 0xffff
    s_mov_b32 s26, 1572864
    s_mov_b32 s27, 0x20000
    s_lshl_b32 s3, s2, 8
    v_add_u32 v1, s3, v0
    v_lshlrev_b32 v2, 4, v1
    s_mov_b32 s40, 0
    buffer_load_dwordx4 v[4:7], v2, s[20:23], s40 offen
    s_mov_b32 s40, 3145728
    buffer_load_dwordx4 v[8:11], v2, s[20:23], s40 offen
    s_mov_b32 s40, 6291456
    buffer_load_dwordx4 v[12:15], v2, s[20:23], s40 offen
    s_mov_b32 s40, 9437184
    buffer_load_dwordx4 v[16:19], v2, s[20:23], s40 offen
    v_lshlrev_b32 v3, 2, v1
    v_and_b32 v20, 511, v3
    v_lshrrev_b32 v21, 9, v3
    v_cmp_le_u32 vcc, 768, v21
    v_cndmask_b32 v22, 0, 1, vcc
    v_mul_u32_u24 v23, 768, v22
    v_sub_u32 v21, v21, v23
    v_lshlrev_b32 v21, 11, v21
    v_lshl_add_u32 v21, v22, 10, v21
    v_lshl_add_u32 v21, v20, 1, v21
    s_waitcnt vmcnt(0)
    v_add_f32 v4, v4, v8
    v_add_f32 v12, v12, v16
    v_add_f32 v4, v4, v12
    v_add_f32 v5, v5, v9
    v_add_f32 v13, v13, v17
    v_add_f32 v5, v5, v13
    v_add_f32 v6, v6, v10
    v_add_f32 v14, v14, v18
    v_add_f32 v6, v6, v14
    v_add_f32 v7, v7, v11
    v_add_f32 v15, v15, v19
    v_add_f32 v7, v7, v15
    v_cvt_pk_bf16_f32 v4, v4, v5
    v_cvt_pk_bf16_f32 v5, v6, v7
    buffer_store_dwordx2 v[4:5], v21, s[24:27], 0 offen
K3_exit:
    s_endpgm
.section .rodata,"a"
.p2align 6
.amdhsa_kernel attn_kernel
  .amdhsa_next_free_vgpr 224
  .amdhsa_next_free_sgpr 64
  .amdhsa_accum_offset 224
  .amdhsa_group_segment_fixed_size 0
  .amdhsa_kernarg_size 104
  .amdhsa_user_sgpr_count 2
  .amdhsa_user_sgpr_kernarg_segment_ptr 1
  .amdhsa_system_sgpr_workgroup_id_x 1
.end_amdhsa_kernel
.p2align 6
.amdhsa_kernel oproj_kernel
  .amdhsa_next_free_vgpr 224
  .amdhsa_next_free_sgpr 64
  .amdhsa_accum_offset 224
  .amdhsa_group_segment_fixed_size 0
  .amdhsa_kernarg_size 104
  .amdhsa_user_sgpr_count 2
  .amdhsa_user_sgpr_kernarg_segment_ptr 1
  .amdhsa_system_sgpr_workgroup_id_x 1
.end_amdhsa_kernel
.p2align 6
.amdhsa_kernel reduce_kernel
  .amdhsa_next_free_vgpr 32
  .amdhsa_next_free_sgpr 64
  .amdhsa_accum_offset 32
  .amdhsa_group_segment_fixed_size 0
  .amdhsa_kernarg_size 104
  .amdhsa_user_sgpr_count 2
  .amdhsa_user_sgpr_kernarg_segment_ptr 1
  .amdhsa_system_sgpr_workgroup_id_x 1
.end_amdhsa_kernel
```
